```python
import torch

def _softmax(x, axis=-1):
    return torch.softmax(x, dim=axis)
def _gelu(x):
    return torch.nn.functional.gelu(x, approximate="tanh")
def _silu(x):
    return torch.nn.functional.silu(x)
def _sigmoid(x):
    return torch.sigmoid(x)
def _layernorm(x, axis=-1, eps=1e-5):
    m = x.mean(dim=axis, keepdim=True)
    v = x.var(dim=axis, keepdim=True, unbiased=False)
    return (x - m) / torch.sqrt(v + eps)
def _scatter_add(tgt, idx, src, axis=0):
    return tgt.clone().index_add_(axis, idx, src)
def _segment_sum(src, seg, n):
    out = torch.zeros((n,) + src.shape[1:], dtype=src.dtype)
    return out.index_add_(0, seg, src)
def _pad(x, pw):
    flat = tuple(v for pair in reversed(pw) for v in pair)
    return torch.nn.functional.pad(x, flat)

kernel_name = 'parallel_sum__sliding_block_cached__dense_activation_silu__decode'

def setup_inputs():

    _w = (lambda a: (lambda t: t.to(torch.bfloat16) if t.is_floating_point() else t)(torch.as_tensor(a)))
    def _A_setup():
        B, Sq, D = 1, 1, 512
        Hq, Hkv, Sk, Dh = 32, 8, 65536, 128
        assert Hq % Hkv == 0, (Hq, Hkv)
        return {
            "x": _w((lambda *s: torch.randn(*s, dtype=torch.bfloat16) * 0.05)(B, Sq, D)),
            "k_cache": _w((lambda *s: torch.randn(*s, dtype=torch.bfloat16) * 3.2)(B, Hkv, Sk, Dh)),
            "v_cache": _w((lambda *s: torch.randn(*s, dtype=torch.bfloat16) * 0.8)(B, Hkv, Sk, Dh)),
            "wq": _w((lambda *s: torch.randn(*s, dtype=torch.bfloat16) * 3.2)(D, Hq * Dh) * (D ** -0.5)),
            "wo": _w((lambda *s: torch.randn(*s, dtype=torch.bfloat16) * 0.8)(Hq * Dh, D) * ((Hq * Dh) ** -0.5)),
        }
    _A_in = _A_setup()

    def _B_setup():
        B, S, D, F = 1, 1, 512, 1792
        return {
            "x": _w((lambda *s: torch.randn(*s, dtype=torch.bfloat16) * 0.05)(B, S, D)),
            "w1": _w((lambda *s: torch.randn(*s, dtype=torch.bfloat16) * 3.2)(D, F) * (D ** -0.5)),
            "w2": _w((lambda *s: torch.randn(*s, dtype=torch.bfloat16) * 0.4)(F, D) * (F ** -0.5)),
        }
    _B_in = _B_setup()

    return {
        "A_x": _A_in["x"],
        "A_k_cache": _A_in["k_cache"],
        "A_v_cache": _A_in["v_cache"],
        "A_wq": _A_in["wq"],
        "A_wo": _A_in["wo"],
        "B_x": _B_in["x"],
        "B_w1": _B_in["w1"],
        "B_w2": _B_in["w2"],
    }

def reference(A_x, A_k_cache, A_v_cache, A_wq, A_wo, B_x, B_w1, B_w2):
    def _A_ref(x, k_cache, v_cache, wq, wo):
        B, Sq, D = x.shape
        Hq, Dh = 32, 128
        Hkv, Sk = k_cache.shape[1], k_cache.shape[2]
        W = min(4096, max(256, Sk // 4))
        rep = Hq // Hkv
        q = (lambda x, *d: x.permute(*d))((x @ wq).reshape(B, Sq, Hq, Dh), 0, 2, 1, 3)
        k = (lambda x, n, axis: torch.repeat_interleave(x, n, dim=axis))(k_cache[:, :, Sk - W:, :], rep, axis=1)
        v = (lambda x, n, axis: torch.repeat_interleave(x, n, dim=axis))(v_cache[:, :, Sk - W:, :], rep, axis=1)
        scores = torch.einsum("bhqd,bhkd->bhqk", q, k) * (Dh ** -0.5)
        p = _softmax(scores, axis=-1)
        o = torch.einsum("bhqk,bhkd->bhqd", p, v)
        return (lambda x, *d: x.permute(*d))(o, 0, 2, 1, 3).reshape(B, Sq, Hq * Dh) @ wo

    def _B_ref(x, w1, w2):
        h = torch.einsum("bsd,df->bsf", x, w1)
        h = _silu(h)
        out = torch.einsum("bsf,fd->bsd", h, w2)
        return out

    x = A_x
    xn = _layernorm(x, axis=-1)
    return x + _A_ref(xn, A_k_cache, A_v_cache, A_wq, A_wo) + _B_ref(xn, B_w1, B_w2)
```

```asm
; @launch grid=(256,1,1) block=(512,1,1) lds=20480
.amdgcn_target "amdgcn-amd-amdhsa--gfx950"
.text
.globl parallel_sum__sliding_block_cached__dense_activation_silu__decode_kernel
.p2align 12
.type parallel_sum__sliding_block_cached__dense_activation_silu__decode_kernel,@function
.set CODE_BYTES, L_code_end - parallel_sum__sliding_block_cached__dense_activation_silu__decode_kernel
parallel_sum__sliding_block_cached__dense_activation_silu__decode_kernel:
    s_cmp_ge_u32 s2, 256
    s_cbranch_scc1 L_end
    s_load_dwordx16 s[4:19], s[0:1], 0
    s_load_dwordx2 s[20:21], s[0:1], 64
    s_load_dwordx2 s[24:25], s[0:1], 80
    v_lshrrev_b32 v22, 6, v0
    s_getpc_b64 s[22:23]
    v_readfirstlane_b32 s40, v22
    v_and_b32 v0, 255, v0
    v_and_b32 v22, 3, v22
    v_and_b32 v1, 63, v0
    s_and_b32 s28, s40, 3
    s_and_b32 s26, s2, 7
    s_bfe_u32 s27, s2, 0x40003
    v_lshlrev_b32 v2, 4, v1
    s_getreg_b32 s59, hwreg(HW_REG_XCC_ID)
    s_mov_b32 s30, 0x05040100
    s_mov_b32 s31, 0x07060302
    s_mov_b32 s48, 0xf8000
    v_and_b32 v16, 3, v0
    v_lshlrev_b32 v16, 4, v16
    v_lshrrev_b32 v14, 2, v0
    s_and_b32 s59, s59, 15
    s_lshl_b32 s41, s26, 24
    s_lshl_b32 s42, s27, 16
    s_add_u32 s41, s41, s42
    s_add_u32 s41, s41, 0xF00000
    v_lshl_add_u32 v15, v22, 14, s41
    s_cmp_ge_u32 s2, 128
    s_cbranch_scc1 L_att
    s_cmp_ge_u32 s40, 4
    s_cbranch_scc1 L_ffn
    s_and_b32 s37, s27, 1
    s_lshl_b32 s38, s37, 3
    v_lshl_add_u32 v7, v14, 4, s38
    v_xor_b32 v10, 8, v7
    s_lshl_b32 s37, s37, 15
    s_lshl_b32 s35, s26, 10
    s_lshl_b32 s36, s27, 6
    s_add_u32 s35, s35, s36
    s_add_u32 s35, s35, s37
    v_lshl_add_u32 v156, v14, 16, s35
    v_add_u32 v156, v16, v156
    v_xor_b32 v170, 0x8000, v156
    s_waitcnt lgkmcnt(0)
    global_load_dwordx4 v[24:27], v2, s[4:5]
    global_load_dwordx2 v[28:29], v7, s[4:5]
    global_load_dwordx2 v[30:31], v10, s[4:5]
    global_load_dwordx4 v[36:39], v156, s[10:11]
    v_add_u32 v156, 0x2000, v156
    s_nop 1
    global_load_dwordx4 v[40:43], v156, s[10:11]
    v_add_u32 v156, 0x2000, v156
    s_nop 1
    global_load_dwordx4 v[44:47], v156, s[10:11]
    v_add_u32 v156, 0x2000, v156
    s_nop 1
    global_load_dwordx4 v[48:51], v156, s[10:11]
    s_load_dword s29, s[24:25], s48
    s_branch L_proj2
L_ffn:
    s_setprio 2
    s_min_u32 s32, s27, 13
    s_and_b32 s34, s32, 1
    s_lshl_b32 s35, s34, 9
    v_lshl_add_u32 v11, v14, 3, s35
    v_mov_b32 v12, 0
    v_mov_b32 v13, 0
    ds_write_b64 v12, v[12:13] offset:1536
    s_waitcnt lgkmcnt(0)
    s_load_dword s29, s[24:25], s48
    s_barrier
    global_load_dwordx4 v[24:27], v2, s[4:5]
    global_load_dwordx2 v[32:33], v11, s[4:5]
    s_branch L_ffn2
L_att:
    s_cmp_lt_u32 s40, 4
    s_cbranch_scc1 L_nocp
    v_lshlrev_b32 v4, 7, v0
    v_cmp_gt_u32 vcc, CODE_BYTES-128, v4
    s_and_b64 exec, exec, vcc
    s_cbranch_execz L_nocp
    global_load_dword v20, v4, s[22:23]
L_nocp:
    s_mov_b64 exec, -1
    v_bfe_u32 v17, v0, 2, 2
    v_bfe_u32 v19, v0, 4, 2
    v_lshlrev_b32 v166, 5, v19
    v_lshl_add_u32 v167, v22, 11, v2
    s_lshl_b32 s52, s26, 11
    s_lshl_b32 s53, s27, 7
    s_lshl_b32 s54, s28, 4
    s_add_u32 s53, s53, s52
    s_add_u32 s53, s53, s54
    s_add_u32 s58, s53, 0xf0000
    s_mov_b32 s57, s40
    s_lshl_b32 s32, s27, 10
    s_add_u32 s33, s32, 1024
    s_and_b32 s33, s33, 0x3fff
    s_add_u32 s34, s33, 1024
    s_and_b32 s34, s34, 0x3fff
    s_add_u32 s35, s34, 1024
    s_and_b32 s35, s35, 0x3fff
    s_add_u32 s36, s35, 1024
    s_and_b32 s36, s36, 0x3fff
    s_add_u32 s37, s36, 1024
    s_and_b32 s37, s37, 0x3fff
    s_add_u32 s38, s37, 1024
    s_and_b32 s38, s38, 0x3fff
    s_add_u32 s39, s38, 1024
    s_and_b32 s39, s39, 0x3fff
    s_add_u32 s40, s39, 1024
    s_and_b32 s40, s40, 0x3fff
    s_add_u32 s41, s40, 1024
    s_and_b32 s41, s41, 0x3fff
    s_add_u32 s42, s41, 1024
    s_and_b32 s42, s42, 0x3fff
    s_add_u32 s43, s42, 1024
    s_and_b32 s43, s43, 0x3fff
    s_add_u32 s44, s43, 1024
    s_and_b32 s44, s44, 0x3fff
    s_add_u32 s45, s44, 1024
    s_and_b32 s45, s45, 0x3fff
    s_add_u32 s46, s45, 1024
    s_and_b32 s46, s46, 0x3fff
    s_add_u32 s47, s46, 1024
    s_and_b32 s47, s47, 0x3fff
    s_cmp_ge_u32 s57, 4
    s_cbranch_scc1 L_val
    v_lshl_add_u32 v18, v17, 8, v16
    v_lshl_add_u32 v18, v19, 6, v18
    v_add_u32 v124, v18, v15
    s_lshl_b32 s50, s26, 7
    s_lshl_b32 s51, s27, 3
    s_add_u32 s50, s50, s51
    s_and_b32 s51, s28, 1
    s_lshl2_add_u32 s50, s51, s50
    s_lshl_b32 s52, s26, 10
    s_lshl_b32 s53, s27, 18
    s_add_u32 s52, s52, s53
    s_add_u32 s52, s52, 384
    v_lshl_add_u32 v6, v22, 16, s52
    v_lshl_add_u32 v6, v1, 13, v6
    s_mov_b64 exec, 0xff
    s_waitcnt lgkmcnt(0)
    global_load_dword v20, v6, s[10:11]
    s_mov_b64 exec, -1
    s_load_dword s29, s[24:25], s48
    s_load_dword s15, s[4:5], s50
    s_mov_b32 s14, 0x40000
    s_mov_b32 s3, 1
    s_add_u32 s60, s24, 0x10000
    s_addc_u32 s61, s25, 0
    s_lshl_b32 s52, s26, 11
    s_add_u32 s52, s52, 0xc0000
    v_lshl_add_u32 v125, v18, 1, s52
    v_and_b32 v7, 15, v0
    v_mov_b32 v127, s58
    v_lshlrev_b32 v126, 5, v17
    v_lshl_add_u32 v126, v22, 3, v126
    s_lshl_b32 s53, s26, 8
    s_add_u32 s53, s53, 0xec000
    v_lshl_add_u32 v131, v7, 2, s53
    s_lshr_b32 s53, s50, 8
    s_lshl_b32 s53, s53, 15
    s_and_b32 s54, s50, 255
    s_lshl_b32 s54, s54, 2
    s_add_u32 s53, s53, 0x80000
    v_and_b32 v8, 31, v0
    v_lshl_add_u32 v128, v8, 7, s54
    v_and_b32 v128, 1023, v128
    v_add_u32 v128, s53, v128
    v_lshl_add_u32 v128, v8, 10, v128
    v_bfe_u32 v8, v0, 5, 1
    v_lshl_add_u32 v128, v8, 17, v128
    v_bfe_u32 v8, v0, 4, 1
    v_lshl_add_u32 v129, v8, 1, s50
    v_cmp_eq_u32 vcc, 0, v8
    s_lshl_b32 s1, s26, 10
    s_add_u32 s1, s1, 0xe2000
    s_lshl_b32 s55, s28, 4
    s_setprio 2
    s_waitcnt lgkmcnt(0)
    v_add_u32 v4, s32, v124
    global_load_dwordx4 v[24:27], v4, s[6:7] nt
    v_add_u32 v5, s33, v124
    global_load_dwordx4 v[28:31], v5, s[6:7] nt
    v_add_u32 v4, s34, v124
    global_load_dwordx4 v[32:35], v4, s[6:7] nt
    v_add_u32 v5, s35, v124
    global_load_dwordx4 v[36:39], v5, s[6:7] nt
    v_add_u32 v4, s36, v124
    global_load_dwordx4 v[40:43], v4, s[6:7] nt
    v_add_u32 v5, s37, v124
    global_load_dwordx4 v[44:47], v5, s[6:7] nt
    v_add_u32 v4, s38, v124
    global_load_dwordx4 v[48:51], v4, s[6:7] nt
    v_add_u32 v5, s39, v124
    global_load_dwordx4 v[52:55], v5, s[6:7] nt
    v_add_u32 v4, s40, v124
    global_load_dwordx4 v[56:59], v4, s[6:7] nt
    v_add_u32 v5, s41, v124
    global_load_dwordx4 v[60:63], v5, s[6:7] nt
    v_add_u32 v4, s42, v124
    global_load_dwordx4 v[64:67], v4, s[6:7] nt
    v_add_u32 v5, s43, v124
    global_load_dwordx4 v[68:71], v5, s[6:7] nt
    v_add_u32 v4, s44, v124
    global_load_dwordx4 v[72:75], v4, s[6:7] nt
    v_add_u32 v5, s45, v124
    global_load_dwordx4 v[76:79], v5, s[6:7] nt
    v_add_u32 v4, s46, v124
    global_load_dwordx4 v[80:83], v4, s[6:7] nt
    v_add_u32 v5, s47, v124
    global_load_dwordx4 v[84:87], v5, s[6:7] nt
    s_barrier
    s_waitcnt lgkmcnt(0)
    s_lshl_b32 s52, s15, 16
    s_and_b32 s53, s15, 0xffff0000
    v_mov_b32 v6, s52
    v_mov_b32 v7, s53
    v_cndmask_b32 v130, v7, v6, vcc
    s_mov_b32 s48, 0x3db504f3
    s_mov_b32 s49, 0x3db504f3
    s_mov_b32 s50, 0x3fb8aa3b
    s_mov_b32 s51, 0x3fb8aa3b
    s_mul_i32 s29, s29, 0x9E3779B1
    s_add_u32 s29, s29, 0x7F4A7C15
    s_xor_b32 s59, s59, s29
    v_mov_b32 v3, s29
    v_mov_b32 v21, s59
    s_mov_b32 s0, 16
L_qf_5:
    s_load_dwordx16 s[32:47], s[24:25], s1
    s_mov_b64 exec, -1
    s_add_u32 s1, s1, 64
    s_sub_u32 s0, s0, 1
    s_cmp_eq_u32 s0, 0
    s_waitcnt lgkmcnt(0)
    s_cbranch_scc1 L_qfk_6
    v_cmpx_eq_u32 vcc, s32, v21
    v_cmpx_eq_u32 vcc, s33, v21
    v_cmpx_eq_u32 vcc, s34, v21
    v_cmpx_eq_u32 vcc, s35, v21
    v_cmpx_eq_u32 vcc, s36, v21
    v_cmpx_eq_u32 vcc, s37, v21
    v_cmpx_eq_u32 vcc, s38, v21
    v_cmpx_eq_u32 vcc, s39, v21
    v_cmpx_eq_u32 vcc, s40, v21
    v_cmpx_eq_u32 vcc, s41, v21
    v_cmpx_eq_u32 vcc, s42, v21
    v_cmpx_eq_u32 vcc, s43, v21
    v_cmpx_eq_u32 vcc, s44, v21
    v_cmpx_eq_u32 vcc, s45, v21
    v_cmpx_eq_u32 vcc, s46, v21
    v_cmpx_eq_u32 vcc, s47, v21
    s_cbranch_execz L_qf_5
L_qfk_6:
    global_load_dwordx4 v[104:107], v125, s[24:25] offset:0 sc1
    global_load_dwordx4 v[108:111], v125, s[24:25] offset:16 sc1
    s_barrier
    s_waitcnt vmcnt(0)
    v_cmpx_eq_u32 vcc, v21, v105
    v_cmpx_eq_u32 vcc, v21, v107
    v_cmpx_eq_u32 vcc, v21, v109
    v_cmpx_eq_u32 vcc, v21, v111
    s_andn2_b64 s[22:23], -1, exec
    s_cbranch_scc1 L_qs_7
L_qk_9:
    v_mov_b32 v112, v104
    v_mov_b32 v113, v106
    v_mov_b32 v114, v108
    v_mov_b32 v115, v110
    v_mov_b32 v14, s3
    v_mov_b32 v15, 0
    v_mfma_f32_16x16x32_bf16 v[24:27], v[24:27], v[112:115], 0
    v_mfma_f32_16x16x32_bf16 v[28:31], v[28:31], v[112:115], 0
    v_mfma_f32_16x16x32_bf16 v[32:35], v[32:35], v[112:115], 0
    v_mfma_f32_16x16x32_bf16 v[36:39], v[36:39], v[112:115], 0
    v_mfma_f32_16x16x32_bf16 v[40:43], v[40:43], v[112:115], 0
    v_mfma_f32_16x16x32_bf16 v[44:47], v[44:47], v[112:115], 0
    v_mfma_f32_16x16x32_bf16 v[48:51], v[48:51], v[112:115], 0
    v_mfma_f32_16x16x32_bf16 v[52:55], v[52:55], v[112:115], 0
    v_mfma_f32_16x16x32_bf16 v[56:59], v[56:59], v[112:115], 0
    v_mfma_f32_16x16x32_bf16 v[60:63], v[60:63], v[112:115], 0
    v_mfma_f32_16x16x32_bf16 v[64:67], v[64:67], v[112:115], 0
    v_mfma_f32_16x16x32_bf16 v[68:71], v[68:71], v[112:115], 0
    v_mfma_f32_16x16x32_bf16 v[72:75], v[72:75], v[112:115], 0
    v_mfma_f32_16x16x32_bf16 v[76:79], v[76:79], v[112:115], 0
    v_mfma_f32_16x16x32_bf16 v[80:83], v[80:83], v[112:115], 0
    v_mfma_f32_16x16x32_bf16 v[84:87], v[84:87], v[112:115], 0
    ds_write_b32 v15, v14 offset:1280
    v_mov_b32_dpp v88, v24 quad_perm:[0,0,0,0] row_mask:0xf bank_mask:0xf
    v_mov_b32_dpp v89, v28 quad_perm:[0,0,0,0] row_mask:0xf bank_mask:0xf
    v_mov_b32_dpp v90, v32 quad_perm:[0,0,0,0] row_mask:0xf bank_mask:0xf
    v_mov_b32_dpp v91, v36 quad_perm:[0,0,0,0] row_mask:0xf bank_mask:0xf
    v_mov_b32_dpp v92, v40 quad_perm:[0,0,0,0] row_mask:0xf bank_mask:0xf
    v_mov_b32_dpp v93, v44 quad_perm:[0,0,0,0] row_mask:0xf bank_mask:0xf
    v_mov_b32_dpp v94, v48 quad_perm:[0,0,0,0] row_mask:0xf bank_mask:0xf
    v_mov_b32_dpp v95, v52 quad_perm:[0,0,0,0] row_mask:0xf bank_mask:0xf
    v_add_f32_dpp v88, v25, v88 quad_perm:[1,1,1,1] row_mask:0xf bank_mask:0xf
    v_add_f32_dpp v89, v29, v89 quad_perm:[1,1,1,1] row_mask:0xf bank_mask:0xf
    v_add_f32_dpp v90, v33, v90 quad_perm:[1,1,1,1] row_mask:0xf bank_mask:0xf
    v_add_f32_dpp v91, v37, v91 quad_perm:[1,1,1,1] row_mask:0xf bank_mask:0xf
    v_add_f32_dpp v92, v41, v92 quad_perm:[1,1,1,1] row_mask:0xf bank_mask:0xf
    v_add_f32_dpp v93, v45, v93 quad_perm:[1,1,1,1] row_mask:0xf bank_mask:0xf
    v_add_f32_dpp v94, v49, v94 quad_perm:[1,1,1,1] row_mask:0xf bank_mask:0xf
    v_add_f32_dpp v95, v53, v95 quad_perm:[1,1,1,1] row_mask:0xf bank_mask:0xf
    v_add_f32_dpp v88, v26, v88 quad_perm:[2,2,2,2] row_mask:0xf bank_mask:0xf
    v_add_f32_dpp v89, v30, v89 quad_perm:[2,2,2,2] row_mask:0xf bank_mask:0xf
    v_add_f32_dpp v90, v34, v90 quad_perm:[2,2,2,2] row_mask:0xf bank_mask:0xf
    v_add_f32_dpp v91, v38, v91 quad_perm:[2,2,2,2] row_mask:0xf bank_mask:0xf
    v_add_f32_dpp v92, v42, v92 quad_perm:[2,2,2,2] row_mask:0xf bank_mask:0xf
    v_add_f32_dpp v93, v46, v93 quad_perm:[2,2,2,2] row_mask:0xf bank_mask:0xf
    v_add_f32_dpp v94, v50, v94 quad_perm:[2,2,2,2] row_mask:0xf bank_mask:0xf
    v_add_f32_dpp v95, v54, v95 quad_perm:[2,2,2,2] row_mask:0xf bank_mask:0xf
    v_add_f32_dpp v88, v27, v88 quad_perm:[3,3,3,3] row_mask:0xf bank_mask:0xf
    v_add_f32_dpp v89, v31, v89 quad_perm:[3,3,3,3] row_mask:0xf bank_mask:0xf
    v_add_f32_dpp v90, v35, v90 quad_perm:[3,3,3,3] row_mask:0xf bank_mask:0xf
    v_add_f32_dpp v91, v39, v91 quad_perm:[3,3,3,3] row_mask:0xf bank_mask:0xf
    v_add_f32_dpp v92, v43, v92 quad_perm:[3,3,3,3] row_mask:0xf bank_mask:0xf
    v_add_f32_dpp v93, v47, v93 quad_perm:[3,3,3,3] row_mask:0xf bank_mask:0xf
    v_add_f32_dpp v94, v51, v94 quad_perm:[3,3,3,3] row_mask:0xf bank_mask:0xf
    v_add_f32_dpp v95, v55, v95 quad_perm:[3,3,3,3] row_mask:0xf bank_mask:0xf
    v_mov_b32_dpp v96, v56 quad_perm:[0,0,0,0] row_mask:0xf bank_mask:0xf
    v_mov_b32_dpp v97, v60 quad_perm:[0,0,0,0] row_mask:0xf bank_mask:0xf
    v_mov_b32_dpp v98, v64 quad_perm:[0,0,0,0] row_mask:0xf bank_mask:0xf
    v_mov_b32_dpp v99, v68 quad_perm:[0,0,0,0] row_mask:0xf bank_mask:0xf
    v_mov_b32_dpp v100, v72 quad_perm:[0,0,0,0] row_mask:0xf bank_mask:0xf
    v_mov_b32_dpp v101, v76 quad_perm:[0,0,0,0] row_mask:0xf bank_mask:0xf
    v_mov_b32_dpp v102, v80 quad_perm:[0,0,0,0] row_mask:0xf bank_mask:0xf
    v_mov_b32_dpp v103, v84 quad_perm:[0,0,0,0] row_mask:0xf bank_mask:0xf
    v_add_f32_dpp v96, v57, v96 quad_perm:[1,1,1,1] row_mask:0xf bank_mask:0xf
    v_add_f32_dpp v97, v61, v97 quad_perm:[1,1,1,1] row_mask:0xf bank_mask:0xf
    v_add_f32_dpp v98, v65, v98 quad_perm:[1,1,1,1] row_mask:0xf bank_mask:0xf
    v_add_f32_dpp v99, v69, v99 quad_perm:[1,1,1,1] row_mask:0xf bank_mask:0xf
    v_add_f32_dpp v100, v73, v100 quad_perm:[1,1,1,1] row_mask:0xf bank_mask:0xf
    v_add_f32_dpp v101, v77, v101 quad_perm:[1,1,1,1] row_mask:0xf bank_mask:0xf
    v_add_f32_dpp v102, v81, v102 quad_perm:[1,1,1,1] row_mask:0xf bank_mask:0xf
    v_add_f32_dpp v103, v85, v103 quad_perm:[1,1,1,1] row_mask:0xf bank_mask:0xf
    v_add_f32_dpp v96, v58, v96 quad_perm:[2,2,2,2] row_mask:0xf bank_mask:0xf
    v_add_f32_dpp v97, v62, v97 quad_perm:[2,2,2,2] row_mask:0xf bank_mask:0xf
    v_add_f32_dpp v98, v66, v98 quad_perm:[2,2,2,2] row_mask:0xf bank_mask:0xf
    v_add_f32_dpp v99, v70, v99 quad_perm:[2,2,2,2] row_mask:0xf bank_mask:0xf
    v_add_f32_dpp v100, v74, v100 quad_perm:[2,2,2,2] row_mask:0xf bank_mask:0xf
    v_add_f32_dpp v101, v78, v101 quad_perm:[2,2,2,2] row_mask:0xf bank_mask:0xf
    v_add_f32_dpp v102, v82, v102 quad_perm:[2,2,2,2] row_mask:0xf bank_mask:0xf
    v_add_f32_dpp v103, v86, v103 quad_perm:[2,2,2,2] row_mask:0xf bank_mask:0xf
    v_add_f32_dpp v96, v59, v96 quad_perm:[3,3,3,3] row_mask:0xf bank_mask:0xf
    v_add_f32_dpp v97, v63, v97 quad_perm:[3,3,3,3] row_mask:0xf bank_mask:0xf
    v_add_f32_dpp v98, v67, v98 quad_perm:[3,3,3,3] row_mask:0xf bank_mask:0xf
    v_add_f32_dpp v99, v71, v99 quad_perm:[3,3,3,3] row_mask:0xf bank_mask:0xf
    v_add_f32_dpp v100, v75, v100 quad_perm:[3,3,3,3] row_mask:0xf bank_mask:0xf
    v_add_f32_dpp v101, v79, v101 quad_perm:[3,3,3,3] row_mask:0xf bank_mask:0xf
    v_add_f32_dpp v102, v83, v102 quad_perm:[3,3,3,3] row_mask:0xf bank_mask:0xf
    v_add_f32_dpp v103, v87, v103 quad_perm:[3,3,3,3] row_mask:0xf bank_mask:0xf
    v_cvt_pk_bf16_f32 v4, v88, v89
    v_cvt_pk_bf16_f32 v5, v90, v91
    v_cvt_pk_bf16_f32 v6, v92, v93
    v_cvt_pk_bf16_f32 v7, v94, v95
    v_cvt_pk_bf16_f32 v8, v96, v97
    v_cvt_pk_bf16_f32 v9, v98, v99
    v_cvt_pk_bf16_f32 v10, v100, v101
    v_cvt_pk_bf16_f32 v11, v102, v103
    v_lshlrev_b32 v88, 16, v4
    v_and_b32 v89, 0xffff0000, v4
    v_lshlrev_b32 v90, 16, v5
    v_and_b32 v91, 0xffff0000, v5
    v_lshlrev_b32 v92, 16, v6
    v_and_b32 v93, 0xffff0000, v6
    v_lshlrev_b32 v94, 16, v7
    v_and_b32 v95, 0xffff0000, v7
    v_lshlrev_b32 v96, 16, v8
    v_and_b32 v97, 0xffff0000, v8
    v_lshlrev_b32 v98, 16, v9
    v_and_b32 v99, 0xffff0000, v9
    v_lshlrev_b32 v100, 16, v10
    v_and_b32 v101, 0xffff0000, v10
    v_lshlrev_b32 v102, 16, v11
    v_and_b32 v103, 0xffff0000, v11
    v_pk_mul_f32 v[88:89], v[88:89], s[48:49]
    v_pk_mul_f32 v[90:91], v[90:91], s[48:49]
    v_pk_mul_f32 v[92:93], v[92:93], s[48:49]
    v_pk_mul_f32 v[94:95], v[94:95], s[48:49]
    v_pk_mul_f32 v[96:97], v[96:97], s[48:49]
    v_pk_mul_f32 v[98:99], v[98:99], s[48:49]
    v_pk_mul_f32 v[100:101], v[100:101], s[48:49]
    v_pk_mul_f32 v[102:103], v[102:103], s[48:49]
    v_cvt_pk_bf16_f32 v4, v88, v89
    v_cvt_pk_bf16_f32 v5, v90, v91
    v_cvt_pk_bf16_f32 v6, v92, v93
    v_cvt_pk_bf16_f32 v7, v94, v95
    v_cvt_pk_bf16_f32 v8, v96, v97
    v_cvt_pk_bf16_f32 v9, v98, v99
    v_cvt_pk_bf16_f32 v10, v100, v101
    v_cvt_pk_bf16_f32 v11, v102, v103
    v_lshlrev_b32 v88, 16, v4
    v_and_b32 v89, 0xffff0000, v4
    v_lshlrev_b32 v90, 16, v5
    v_and_b32 v91, 0xffff0000, v5
    v_lshlrev_b32 v92, 16, v6
    v_and_b32 v93, 0xffff0000, v6
    v_lshlrev_b32 v94, 16, v7
    v_and_b32 v95, 0xffff0000, v7
    v_lshlrev_b32 v96, 16, v8
    v_and_b32 v97, 0xffff0000, v8
    v_lshlrev_b32 v98, 16, v9
    v_and_b32 v99, 0xffff0000, v9
    v_lshlrev_b32 v100, 16, v10
    v_and_b32 v101, 0xffff0000, v10
    v_lshlrev_b32 v102, 16, v11
    v_and_b32 v103, 0xffff0000, v11
    v_max3_f32 v4, v88, v89, v90
    v_max3_f32 v5, v91, v92, v93
    v_max3_f32 v6, v94, v95, v96
    v_max3_f32 v7, v97, v98, v99
    v_max3_f32 v8, v100, v101, v102
    v_max3_f32 v4, v4, v5, v6
    v_max3_f32 v7, v7, v8, v103
    v_max_f32 v12, v4, v7
    v_mov_b32 v4, v12
    s_nop 1
    v_permlane32_swap_b32 v12, v4
    v_max_f32 v12, v12, v4
    v_mov_b32 v4, v12
    s_nop 1
    v_permlane16_swap_b32 v12, v4
    v_max_f32 v12, v12, v4
    v_pk_add_f32 v[88:89], v[88:89], v[12:13] op_sel_hi:[1,0] neg_lo:[0,1] neg_hi:[0,1]
    v_pk_add_f32 v[90:91], v[90:91], v[12:13] op_sel_hi:[1,0] neg_lo:[0,1] neg_hi:[0,1]
    v_pk_add_f32 v[92:93], v[92:93], v[12:13] op_sel_hi:[1,0] neg_lo:[0,1] neg_hi:[0,1]
    v_pk_add_f32 v[94:95], v[94:95], v[12:13] op_sel_hi:[1,0] neg_lo:[0,1] neg_hi:[0,1]
    v_pk_add_f32 v[96:97], v[96:97], v[12:13] op_sel_hi:[1,0] neg_lo:[0,1] neg_hi:[0,1]
    v_pk_add_f32 v[98:99], v[98:99], v[12:13] op_sel_hi:[1,0] neg_lo:[0,1] neg_hi:[0,1]
    v_pk_add_f32 v[100:101], v[100:101], v[12:13] op_sel_hi:[1,0] neg_lo:[0,1] neg_hi:[0,1]
    v_pk_add_f32 v[102:103], v[102:103], v[12:13] op_sel_hi:[1,0] neg_lo:[0,1] neg_hi:[0,1]
    v_pk_mul_f32 v[88:89], v[88:89], s[50:51]
    v_pk_mul_f32 v[90:91], v[90:91], s[50:51]
    v_pk_mul_f32 v[92:93], v[92:93], s[50:51]
    v_pk_mul_f32 v[94:95], v[94:95], s[50:51]
    v_pk_mul_f32 v[96:97], v[96:97], s[50:51]
    v_pk_mul_f32 v[98:99], v[98:99], s[50:51]
    v_pk_mul_f32 v[100:101], v[100:101], s[50:51]
    v_pk_mul_f32 v[102:103], v[102:103], s[50:51]
    v_exp_f32 v88, v88
    v_exp_f32 v89, v89
    v_exp_f32 v90, v90
    v_exp_f32 v91, v91
    v_exp_f32 v92, v92
    v_exp_f32 v93, v93
    v_exp_f32 v94, v94
    v_exp_f32 v95, v95
    v_exp_f32 v96, v96
    v_exp_f32 v97, v97
    v_cvt_pk_bf16_f32 v116, v88, v89
    v_exp_f32 v98, v98
    v_exp_f32 v99, v99
    v_cvt_pk_bf16_f32 v117, v90, v91
    v_exp_f32 v100, v100
    v_exp_f32 v101, v101
    v_cvt_pk_bf16_f32 v118, v92, v93
    v_exp_f32 v102, v102
    v_exp_f32 v103, v103
    v_cvt_pk_bf16_f32 v119, v94, v95
    ds_write_b128 v167, v[116:119] offset:10240
    v_cvt_pk_bf16_f32 v120, v96, v97
    v_cvt_pk_bf16_f32 v121, v98, v99
    v_cvt_pk_bf16_f32 v122, v100, v101
    v_cvt_pk_bf16_f32 v123, v102, v103
    ds_write_b128 v167, v[120:123] offset:11264
    v_pk_add_f32 v[4:5], v[88:89], v[90:91]
    v_pk_add_f32 v[6:7], v[92:93], v[94:95]
    v_pk_add_f32 v[8:9], v[96:97], v[98:99]
    v_pk_add_f32 v[10:11], v[100:101], v[102:103]
    v_pk_add_f32 v[4:5], v[4:5], v[6:7]
    v_pk_add_f32 v[8:9], v[8:9], v[10:11]
    v_pk_add_f32 v[4:5], v[4:5], v[8:9]
    v_add_f32 v13, v4, v5
    v_mov_b32 v4, v13
    s_nop 1
    v_permlane32_swap_b32 v13, v4
    v_add_f32 v13, v13, v4
    v_mov_b32 v4, v13
    s_nop 1
    v_permlane16_swap_b32 v13, v4
    v_add_f32 v13, v13, v4
    s_mov_b64 exec, 0x1111
    ds_write_b64 v126, v[12:13] offset:1024
    s_mov_b64 exec, -1
    s_waitcnt lgkmcnt(0)
    s_barrier
    ds_read_b128 v[4:7], v166 offset:1024
    ds_read_b128 v[8:11], v166 offset:1040
    v_mov_b32 v17, s29
    v_mov_b32 v19, s29
    s_waitcnt lgkmcnt(0)
    v_max3_f32 v16, v4, v6, v8
    v_max_f32 v16, v16, v10
    v_sub_f32 v4, v4, v16
    v_sub_f32 v6, v6, v16
    v_sub_f32 v8, v8, v16
    v_sub_f32 v10, v10, v16
    v_mul_f32 v4, s50, v4
    v_mul_f32 v6, s50, v6
    v_mul_f32 v8, s50, v8
    v_mul_f32 v10, s50, v10
    v_exp_f32 v4, v4
    v_exp_f32 v6, v6
    v_exp_f32 v8, v8
    v_exp_f32 v10, v10
    v_mul_f32 v18, v4, v5
    v_fmac_f32 v18, v6, v7
    v_fmac_f32 v18, v8, v9
    v_fmac_f32 v18, v10, v11
    s_lshl_b64 exec, 1, s55
    s_cmp_eq_u32 s3, 0
    s_cbranch_scc1 L_st_10
    global_store_dwordx4 v127, v[16:19], s[24:25]
L_stb_11:
    s_mov_b64 exec, -1
    s_cmp_ge_u32 s28, 2
    s_barrier
    s_cbranch_scc1 L_out
    s_mov_b32 s0, 64
L_af_12:
    global_load_dword v20, v131, s[24:25] sc1
    s_sub_u32 s0, s0, 1
    s_cbranch_scc1 L_afk_13
    s_waitcnt vmcnt(0)
    v_cmp_ne_u32 vcc, v3, v20
    s_cbranch_vccnz L_af_12
L_afk_13:
    global_load_dwordx4 v[12:15], v128, s[24:25] sc1
    s_mov_b64 s[22:23], -1
    s_waitcnt vmcnt(0)
    s_branch L_af_15
L_al_14:
    s_sub_u32 s14, s14, 1
    s_cbranch_scc1 L_end
    s_mov_b64 exec, s[22:23]
    global_load_dwordx4 v[12:15], v128, s[24:25] sc1
    s_waitcnt vmcnt(0)
L_af_15:
    v_cmpx_eq_u32 vcc, v3, v13
    v_cmpx_eq_u32 vcc, v3, v15
    s_andn2_b64 s[22:23], s[22:23], exec
    s_cbranch_scc1 L_al_14
    s_mov_b64 exec, -1
    s_nop 1
    v_permlane16_swap_b32 v12, v14
    v_add_f32 v5, v12, v14
    s_nop 1
    v_add_f32_dpp v5, v5, v5 row_ror:8 row_mask:0xf bank_mask:0xf
    s_nop 1
    v_add_f32_dpp v5, v5, v5 row_ror:4 row_mask:0xf bank_mask:0xf
    s_nop 1
    v_add_f32_dpp v5, v5, v5 row_ror:2 row_mask:0xf bank_mask:0xf
    s_nop 1
    v_add_f32_dpp v5, v5, v5 row_ror:1 row_mask:0xf bank_mask:0xf
    v_cvt_pk_bf16_f32 v5, v5, v5
    v_lshlrev_b32 v5, 16, v5
    v_mov_b32 v4, v5
    s_nop 1
    v_permlane32_swap_b32 v5, v4
    v_add_f32 v5, v130, v5
    v_cvt_pk_bf16_f32 v5, v5, v5
    v_lshlrev_b32 v5, 16, v5
    v_add_f32 v5, v5, v4
    v_cvt_pk_bf16_f32 v5, v5, v5
    s_mov_b64 exec, 0x10001
    global_store_short v129, v5, s[20:21]
    s_cmp_lg_u32 s2, 128
    s_cbranch_scc1 L_out
    v_mov_b32 v6, 0xf8000
    global_store_dword v6, v3, s[24:25]
    s_endpgm
L_val:
    v_add_u32 v160, v2, v15
    s_min_u32 s52, s27, 13
    s_lshl_b32 s54, s26, 12
    s_lshl_b32 s55, s52, 8
    s_add_u32 s54, s54, s55
    s_add_u32 s54, s54, 0xc4000
    s_add_u32 s55, s54, 128
    s_lshl_b32 s52, s26, 11
    s_lshl_b32 s53, s27, 7
    s_add_u32 s52, s52, s53
    s_add_u32 s52, s52, 0xc0000
    s_lshl_b32 s56, s26, 10
    s_lshr_b32 s53, s53, 1
    s_add_u32 s53, s53, s56
    s_add_u32 s53, s53, 0xe2000
    s_cmp_eq_u32 s28, 1
    s_cselect_b32 s52, s53, s52
    s_cmp_eq_u32 s28, 2
    s_cselect_b32 s52, s54, s52
    s_cmp_eq_u32 s28, 3
    s_cselect_b32 s52, s55, s52
    v_mov_b32 v7, s52
    s_waitcnt lgkmcnt(0)
    s_load_dword s29, s[24:25], s48
    global_load_dword v20, v7, s[24:25]
    s_lshl_b32 s52, s26, 16
    s_lshl_b32 s53, s27, 8
    s_add_u32 s52, s52, s53
    v_lshrrev_b32 v6, 4, v0
    v_and_b32 v7, 15, v0
    v_lshl_add_u32 v161, v6, 12, s52
    v_lshl_add_u32 v161, v7, 4, v161
    v_lshlrev_b32 v162, 4, v14
    v_bfe_u32 v8, v0, 1, 1
    v_lshl_add_u32 v162, v8, 10, v162
    v_and_b32 v8, 1, v0
    v_lshl_add_u32 v162, v8, 3, v162
    v_lshl_add_u32 v163, v22, 3, v166
    v_mov_b32 v165, s58
    v_mov_b32 v15, 0
    ds_write_b32 v15, v15 offset:1536
    s_mov_b32 s14, 0x40000
    s_add_u32 s60, s24, 0x10000
    s_addc_u32 s61, s25, 0
    s_lshr_b32 s52, s27, 2
    s_and_b32 s53, s27, 3
    s_lshl_b32 s54, s26, 2
    s_add_u32 s54, s54, s52
    s_lshl_b32 s55, s53, 8
    s_mul_i32 s56, s54, 57344
    s_add_u32 s55, s55, s56
    s_add_u32 s55, s55, 4096
    v_lshl_add_u32 v6, v1, 2, s55
    v_mul_u32_u24 v182, 14336, v22
    v_add_u32 v182, v182, v6
    v_add_u32 v183, 0x2000, v182
    s_lshl_b32 s55, s53, 15
    s_lshl_b32 s56, s54, 10
    s_add_u32 s55, s55, s56
    s_add_u32 s55, s55, 0xa0000
    s_lshl_b32 s56, s54, 7
    v_add_u32 v185, s56, v2
    v_and_b32 v185, 1023, v185
    v_add_u32 v185, s55, v185
    v_lshl_add_u32 v187, v0, 2, s55
    v_min_u32 v8, 13, v7
    s_mul_i32 s55, s52, 56
    s_mul_i32 s56, s28, 14
    s_add_u32 s55, s55, s56
    v_add_u32 v8, s55, v8
    v_lshrrev_b32 v9, 5, v8
    v_and_b32 v8, 31, v8
    s_lshl_b32 s55, s26, 12
    s_add_u32 s55, s55, 0xc4000
    v_lshl_add_u32 v184, v9, 9, s55
    v_lshl_add_u32 v184, v8, 3, v184
    v_bfe_u32 v8, v0, 4, 1
    v_lshl_add_u32 v184, v8, 8, v184
    v_lshlrev_b32 v186, 3, v1
    s_mov_b32 s50, 0x3fb8aa3b
    s_waitcnt lgkmcnt(0)
    s_mul_i32 s29, s29, 0x9E3779B1
    s_add_u32 s29, s29, 0x7F4A7C15
    s_xor_b32 s59, s59, s29
    v_mov_b32 v3, s29
    v_mov_b32 v21, s59
    v_mov_b32 v17, s29
    v_mov_b32 v19, s29
    s_barrier
    v_add_u32 v4, s32, v160
    global_load_dwordx4 v[24:27], v4, s[8:9] nt
    v_add_u32 v5, s33, v160
    global_load_dwordx4 v[28:31], v5, s[8:9] nt
    v_add_u32 v4, s34, v160
    global_load_dwordx4 v[32:35], v4, s[8:9] nt
    v_add_u32 v5, s35, v160
    global_load_dwordx4 v[36:39], v5, s[8:9] nt
    s_barrier
    global_load_dword v20, v161, s[24:25]
    global_load_dword v20, v165, s[24:25]
    global_load_dword v20, v187, s[24:25]
    v_add_u32 v4, s36, v160
    global_load_dwordx4 v[40:43], v4, s[8:9] nt
    v_add_u32 v5, s37, v160
    global_load_dwordx4 v[44:47], v5, s[8:9] nt
    v_add_u32 v4, s38, v160
    global_load_dwordx4 v[48:51], v4, s[8:9] nt
    v_add_u32 v5, s39, v160
    global_load_dwordx4 v[52:55], v5, s[8:9] nt
    v_add_u32 v4, s40, v160
    global_load_dwordx4 v[56:59], v4, s[8:9] nt
    v_add_u32 v5, s41, v160
    global_load_dwordx4 v[60:63], v5, s[8:9] nt
    v_add_u32 v4, s42, v160
    global_load_dwordx4 v[64:67], v4, s[8:9] nt
    v_add_u32 v5, s43, v160
    global_load_dwordx4 v[68:71], v5, s[8:9] nt
    v_add_u32 v4, s44, v160
    global_load_dwordx4 v[72:75], v4, s[8:9] nt
    v_add_u32 v5, s45, v160
    global_load_dwordx4 v[76:79], v5, s[8:9] nt
    v_add_u32 v4, s46, v160
    global_load_dwordx4 v[80:83], v4, s[8:9] nt
    v_add_u32 v5, s47, v160
    global_load_dwordx4 v[84:87], v5, s[8:9] nt
    v_lshlrev_b32 v187, 3, v0
    s_waitcnt vmcnt(17)
    v_perm_b32 v88, v28, v24, s30
    v_perm_b32 v92, v28, v24, s31
    v_perm_b32 v96, v29, v25, s30
    v_perm_b32 v100, v29, v25, s31
    v_perm_b32 v104, v30, v26, s30
    v_perm_b32 v108, v30, v26, s31
    v_perm_b32 v112, v31, v27, s30
    v_perm_b32 v116, v31, v27, s31
    s_waitcnt vmcnt(15)
    v_perm_b32 v89, v36, v32, s30
    v_perm_b32 v93, v36, v32, s31
    v_perm_b32 v97, v37, v33, s30
    v_perm_b32 v101, v37, v33, s31
    v_perm_b32 v105, v38, v34, s30
    v_perm_b32 v109, v38, v34, s31
    v_perm_b32 v113, v39, v35, s30
    v_perm_b32 v117, v39, v35, s31
    s_waitcnt vmcnt(10)
    v_perm_b32 v90, v44, v40, s30
    v_perm_b32 v94, v44, v40, s31
    v_perm_b32 v98, v45, v41, s30
    v_perm_b32 v102, v45, v41, s31
    v_perm_b32 v106, v46, v42, s30
    v_perm_b32 v110, v46, v42, s31
    v_perm_b32 v114, v47, v43, s30
    v_perm_b32 v118, v47, v43, s31
    s_waitcnt vmcnt(8)
    v_perm_b32 v91, v52, v48, s30
    v_perm_b32 v95, v52, v48, s31
    v_perm_b32 v99, v53, v49, s30
    v_perm_b32 v103, v53, v49, s31
    v_perm_b32 v107, v54, v50, s30
    v_perm_b32 v111, v54, v50, s31
    v_perm_b32 v115, v55, v51, s30
    v_perm_b32 v119, v55, v51, s31
    global_load_dword v168, v182, s[18:19] offset:-4096 nt
    global_load_dword v169, v182, s[18:19] offset:-3072 nt
    global_load_dword v170, v182, s[18:19] offset:-2048 nt
    global_load_dword v171, v182, s[18:19] offset:-1024 nt
    global_load_dword v172, v182, s[18:19] offset:0 nt
    global_load_dword v173, v182, s[18:19] offset:1024 nt
    global_load_dword v174, v182, s[18:19] offset:2048 nt
    global_load_dword v175, v182, s[18:19] offset:3072 nt
    global_load_dword v176, v183, s[18:19] offset:-4096 nt
    global_load_dword v177, v183, s[18:19] offset:-3072 nt
    global_load_dword v178, v183, s[18:19] offset:-2048 nt
    global_load_dword v179, v183, s[18:19] offset:-1024 nt
    global_load_dword v180, v183, s[18:19] offset:0 nt
    global_load_dword v181, v183, s[18:19] offset:1024 nt
    s_barrier
    ds_read_b128 v[152:155], v167 offset:10240
    ds_read_b128 v[156:159], v167 offset:11264
    ds_read_b128 v[4:7], v166 offset:1024
    ds_read_b128 v[8:11], v166 offset:1040
    ds_read_b32 v163, v163 offset:1024
    ds_read_b32 v14, v15 offset:1280
    s_waitcnt lgkmcnt(5)
    v_mfma_f32_16x16x32_bf16 v[120:123], v[152:155], v[88:91], 0
    v_mfma_f32_16x16x32_bf16 v[124:127], v[152:155], v[92:95], 0
    v_mfma_f32_16x16x32_bf16 v[128:131], v[152:155], v[96:99], 0
    v_mfma_f32_16x16x32_bf16 v[132:135], v[152:155], v[100:103], 0
    s_waitcnt lgkmcnt(0)
    v_max3_f32 v16, v4, v6, v8
    v_mfma_f32_16x16x32_bf16 v[136:139], v[152:155], v[104:107], 0
    v_max_f32 v16, v16, v10
    v_readfirstlane_b32 s3, v14
    v_mfma_f32_16x16x32_bf16 v[140:143], v[152:155], v[108:111], 0
    v_sub_f32 v163, v163, v16
    v_mul_f32 v163, s50, v163
    v_mfma_f32_16x16x32_bf16 v[144:147], v[152:155], v[112:115], 0
    v_exp_f32 v163, v163
    v_mfma_f32_16x16x32_bf16 v[148:151], v[152:155], v[116:119], 0
    s_waitcnt vmcnt(20)
    v_perm_b32 v24, v60, v56, s30
    v_perm_b32 v28, v60, v56, s31
    v_perm_b32 v32, v61, v57, s30
    v_perm_b32 v36, v61, v57, s31
    v_perm_b32 v40, v62, v58, s30
    v_perm_b32 v44, v62, v58, s31
    v_perm_b32 v48, v63, v59, s30
    v_perm_b32 v52, v63, v59, s31
    s_waitcnt vmcnt(18)
    v_perm_b32 v25, v68, v64, s30
    v_perm_b32 v29, v68, v64, s31
    v_perm_b32 v33, v69, v65, s30
    v_perm_b32 v37, v69, v65, s31
    v_perm_b32 v41, v70, v66, s30
    v_perm_b32 v45, v70, v66, s31
    v_perm_b32 v49, v71, v67, s30
    v_perm_b32 v53, v71, v67, s31
    s_waitcnt vmcnt(16)
    v_perm_b32 v26, v76, v72, s30
    v_perm_b32 v30, v76, v72, s31
    v_perm_b32 v34, v77, v73, s30
    v_perm_b32 v38, v77, v73, s31
    v_perm_b32 v42, v78, v74, s30
    v_perm_b32 v46, v78, v74, s31
    v_perm_b32 v50, v79, v75, s30
    v_perm_b32 v54, v79, v75, s31
    s_waitcnt vmcnt(14)
    v_perm_b32 v27, v84, v80, s30
    v_perm_b32 v31, v84, v80, s31
    v_perm_b32 v35, v85, v81, s30
    v_mfma_f32_16x16x32_bf16 v[120:123], v[156:159], v[24:27], v[120:123]
    v_perm_b32 v39, v85, v81, s31
    v_mfma_f32_16x16x32_bf16 v[124:127], v[156:159], v[28:31], v[124:127]
    v_perm_b32 v43, v86, v82, s30
    v_mfma_f32_16x16x32_bf16 v[128:131], v[156:159], v[32:35], v[128:131]
    v_perm_b32 v47, v86, v82, s31
    v_mfma_f32_16x16x32_bf16 v[132:135], v[156:159], v[36:39], v[132:135]
    v_perm_b32 v51, v87, v83, s30
    v_mfma_f32_16x16x32_bf16 v[136:139], v[156:159], v[40:43], v[136:139]
    v_perm_b32 v55, v87, v83, s31
    v_mfma_f32_16x16x32_bf16 v[140:143], v[156:159], v[44:47], v[140:143]
    v_mul_f32 v88, v120, v163
    v_mfma_f32_16x16x32_bf16 v[144:147], v[156:159], v[48:51], v[144:147]
    v_mul_f32 v89, v124, v163
    v_mfma_f32_16x16x32_bf16 v[148:151], v[156:159], v[52:55], v[148:151]
    v_mul_f32 v90, v128, v163
    v_mul_f32 v91, v132, v163
    ds_write_b128 v167, v[88:91] offset:2048
    v_mul_f32 v92, v136, v163
    s_nop 0
    v_mul_f32 v93, v140, v163
    s_nop 0
    v_mul_f32 v94, v144, v163
    s_nop 0
    v_mul_f32 v95, v148, v163
    ds_write_b128 v167, v[92:95] offset:3072
    s_waitcnt lgkmcnt(0)
    s_barrier
    ds_read2st64_b64 v[4:7], v162 offset0:4 offset1:8
    ds_read2st64_b64 v[8:11], v162 offset0:12 offset1:16
    s_waitcnt lgkmcnt(0)
    v_pk_add_f32 v[4:5], v[4:5], v[6:7]
    v_pk_add_f32 v[8:9], v[8:9], v[10:11]
    v_add_f32 v16, v4, v8
    v_add_f32 v18, v5, v9
    s_cmp_eq_u32 s3, 0
    s_cbranch_scc1 L_st_16
    global_store_dwordx4 v161, v[16:19], s[24:25]
L_stb_17:
    global_load_dwordx2 v[188:189], v184, s[24:25] sc1
    s_waitcnt vmcnt(2)
    v_perm_b32 v24, v169, v168, s30
    v_perm_b32 v25, v169, v168, s31
    v_perm_b32 v26, v171, v170, s30
    v_perm_b32 v27, v171, v170, s31
    v_perm_b32 v28, v173, v172, s30
    v_perm_b32 v29, v173, v172, s31
    v_perm_b32 v30, v175, v174, s30
    v_perm_b32 v31, v175, v174, s31
    v_perm_b32 v32, v177, v176, s30
    v_perm_b32 v33, v177, v176, s31
    v_perm_b32 v34, v179, v178, s30
    v_perm_b32 v35, v179, v178, s31
    v_perm_b32 v36, v181, v180, s30
    v_perm_b32 v37, v181, v180, s31
    s_waitcnt vmcnt(0)
    v_cmpx_eq_u32 vcc, v21, v189
    s_andn2_b64 s[22:23], -1, exec
    s_cbranch_scc1 L_hs_18
L_hk_20:
    s_nop 0
    v_mov_b32 v4, v188
    s_nop 1
    v_permlane16_swap_b32 v188, v4
    v_add_f32 v188, v188, v4
    v_cvt_pk_bf16_f32 v188, v188, v188
    v_lshlrev_b32 v188, 16, v188
    v_mul_f32 v4, 0xbfb8aa3b, v188
    v_exp_f32 v4, v4
    s_nop 0
    v_add_f32 v4, 1.0, v4
    v_rcp_f32 v4, v4
    s_nop 0
    v_mul_f32 v188, v188, v4
    s_nop 1
    v_mov_b32_dpp v4, v188 quad_perm:[1,0,3,2] row_mask:0xf bank_mask:0xf
    v_cvt_pk_bf16_f32 v188, v188, v4
    s_nop 0
    v_readlane_b32 s32, v188, 0
    v_readlane_b32 s33, v188, 2
    v_readlane_b32 s34, v188, 4
    v_readlane_b32 s35, v188, 6
    v_readlane_b32 s36, v188, 8
    v_readlane_b32 s37, v188, 10
    v_readlane_b32 s38, v188, 12
    v_dot2_f32_bf16 v12, v24, s32, 0
    v_dot2_f32_bf16 v13, v25, s32, 0
    v_dot2_f32_bf16 v12, v26, s33, v12
    v_dot2_f32_bf16 v13, v27, s33, v13
    v_dot2_f32_bf16 v12, v28, s34, v12
    v_dot2_f32_bf16 v13, v29, s34, v13
    v_dot2_f32_bf16 v12, v30, s35, v12
    v_dot2_f32_bf16 v13, v31, s35, v13
    v_dot2_f32_bf16 v12, v32, s36, v12
    v_dot2_f32_bf16 v13, v33, s36, v13
    v_dot2_f32_bf16 v12, v34, s37, v12
    v_dot2_f32_bf16 v13, v35, s37, v13
    v_dot2_f32_bf16 v12, v36, s38, v12
    v_dot2_f32_bf16 v13, v37, s38, v13
    v_mov_b32 v5, 1
    s_nop 1
    ds_write_b64 v187, v[12:13] offset:18432
    s_mov_b64 exec, 1
    ds_add_rtn_u32 v14, v15, v5 offset:1536
    s_mov_b64 exec, -1
    s_waitcnt lgkmcnt(0)
    v_readfirstlane_b32 s45, v14
    s_cmp_lg_u32 s45, 3
    s_cbranch_scc1 L_out
    ds_read2st64_b64 v[4:7], v186 offset0:36 offset1:37
    ds_read2st64_b64 v[8:11], v186 offset0:38 offset1:39
    s_waitcnt lgkmcnt(0)
    v_pk_add_f32 v[4:5], v[4:5], v[6:7]
    v_pk_add_f32 v[8:9], v[8:9], v[10:11]
    v_add_f32 v16, v4, v8
    v_add_f32 v18, v5, v9
    global_store_dwordx4 v185, v[16:19], s[24:25] sc1
    s_endpgm
L_proj2:
    s_mov_b32 s14, 0x40000
    s_add_u32 s60, s24, 0x10000
    s_addc_u32 s61, s25, 0
    s_lshr_b32 s37, s27, 2
    s_and_b32 s38, s27, 3
    s_lshl_b32 s39, s26, 2
    s_add_u32 s39, s39, s37
    s_lshl_b32 s40, s38, 8
    s_add_u32 s40, s40, 4096
    v_lshl_add_u32 v7, v1, 2, s40
    s_lshl_b32 s41, s38, 15
    s_lshl_b32 s36, s39, 10
    s_add_u32 s41, s41, s36
    s_lshl_b32 s36, s39, 7
    v_add_u32 v168, s36, v2
    v_and_b32 v168, 1023, v168
    v_lshlrev_b32 v164, 3, v1
    v_lshlrev_b32 v165, 3, v0
    s_lshl_b32 s42, s26, 10
    s_lshl_b32 s36, s27, 2
    s_add_u32 s43, s42, s36
    v_cmp_lt_u32 vcc, 15, v1
    v_and_b32 v161, 3, v0
    v_lshlrev_b32 v161, 5, v161
    v_bfe_u32 v8, v0, 4, 1
    v_lshl_add_u32 v161, v8, 3, v161
    v_bfe_u32 v8, v0, 5, 1
    v_lshl_add_u32 v161, v8, 2, v161
    v_lshl_add_u32 v161, v22, 7, v161
    v_and_b32 v8, 15, v0
    v_lshlrev_b32 v160, 3, v8
    s_lshl_b32 s35, s26, 11
    s_lshl_b32 s36, s27, 7
    s_add_u32 s35, s35, s36
    s_add_u32 s35, s35, 0xc0000
    v_lshl_add_u32 v159, v1, 3, s35
    s_add_u32 s35, s43, 0xe1c00
    v_lshl_add_u32 v9, v1, 6, s35
    v_cndmask_b32 v159, v159, v9, vcc
    s_lshl_b32 s36, s27, 10
    v_lshl_add_u32 v171, v1, 7, s36
    v_and_b32 v171, 0x3fff, v171
    v_xor_b32 v172, 0x2000, v171
    v_add_u32 v171, v15, v171
    v_add_u32 v172, v15, v172
    s_lshl_b32 s35, s39, 17
    v_lshl_add_u32 v158, v22, 15, v7
    v_add_u32 v158, s35, v158
    s_add_u32 s35, s41, 0x80000
    v_add_u32 v168, s35, v168
    v_lshl_add_u32 v167, v0, 2, s35
    s_lshl_b32 s35, s39, 14
    v_lshl_add_u32 v162, v22, 12, s35
    v_add_u32 v162, v2, v162
    s_lshl_b32 s35, s26, 11
    s_lshl_b32 s36, s37, 4
    s_add_u32 s35, s35, s36
    s_add_u32 s35, s35, 0xf0000
    v_and_b32 v8, 48, v0
    v_lshl_add_u32 v163, v8, 3, s35
    s_lshl_b32 s35, s26, 8
    s_lshl_b32 s36, s27, 2
    s_add_u32 s35, s35, s36
    s_add_u32 s35, s35, 0xec000
    v_lshl_add_u32 v169, v22, 6, s35
    s_mov_b32 s50, 0x3fb8aa3b
    s_barrier
    global_load_dwordx4 v[52:55], v170, s[10:11]
    v_add_u32 v170, 0x2000, v170
    s_nop 1
    global_load_dwordx4 v[56:59], v170, s[10:11]
    v_add_u32 v170, 0x2000, v170
    s_nop 1
    global_load_dwordx4 v[60:63], v170, s[10:11]
    v_add_u32 v170, 0x2000, v170
    s_nop 1
    global_load_dwordx4 v[64:67], v170, s[10:11]
    s_waitcnt vmcnt(8)
    v_lshlrev_b32 v4, 16, v24
    v_and_b32 v5, 0xffff0000, v24
    v_lshlrev_b32 v6, 16, v25
    v_and_b32 v7, 0xffff0000, v25
    v_lshlrev_b32 v8, 16, v26
    v_and_b32 v9, 0xffff0000, v26
    v_lshlrev_b32 v10, 16, v27
    v_and_b32 v11, 0xffff0000, v27
    v_pk_add_f32 v[12:13], v[4:5], v[6:7]
    v_pk_add_f32 v[14:15], v[8:9], v[10:11]
    v_pk_add_f32 v[12:13], v[12:13], v[14:15]
    v_add_f32 v12, v12, v13
    s_nop 1
    v_add_f32_dpp v12, v12, v12 row_ror:8 row_mask:0xf bank_mask:0xf
    s_nop 1
    v_add_f32_dpp v12, v12, v12 row_ror:4 row_mask:0xf bank_mask:0xf
    s_nop 1
    v_add_f32_dpp v12, v12, v12 row_ror:2 row_mask:0xf bank_mask:0xf
    s_nop 1
    v_add_f32_dpp v12, v12, v12 row_ror:1 row_mask:0xf bank_mask:0xf
    s_nop 1
    v_add_f32_dpp v12, v12, v12 row_bcast:15 row_mask:0xa bank_mask:0xf
    s_nop 1
    v_add_f32_dpp v12, v12, v12 row_bcast:31 row_mask:0xc bank_mask:0xf
    s_nop 0
    v_readlane_b32 s44, v12, 63
    s_nop 1
    v_mov_b32 v16, 0x3b000000
    v_mul_f32 v14, s44, v16
    v_pk_add_f32 v[4:5], v[4:5], v[14:15] op_sel_hi:[1,0] neg_lo:[0,1] neg_hi:[0,1]
    v_pk_add_f32 v[6:7], v[6:7], v[14:15] op_sel_hi:[1,0] neg_lo:[0,1] neg_hi:[0,1]
    v_pk_add_f32 v[8:9], v[8:9], v[14:15] op_sel_hi:[1,0] neg_lo:[0,1] neg_hi:[0,1]
    v_pk_add_f32 v[10:11], v[10:11], v[14:15] op_sel_hi:[1,0] neg_lo:[0,1] neg_hi:[0,1]
    v_pk_mul_f32 v[12:13], v[4:5], v[4:5]
    v_pk_fma_f32 v[12:13], v[6:7], v[6:7], v[12:13]
    v_pk_fma_f32 v[12:13], v[8:9], v[8:9], v[12:13]
    v_pk_fma_f32 v[12:13], v[10:11], v[10:11], v[12:13]
    v_add_f32 v12, v12, v13
    s_nop 1
    v_add_f32_dpp v12, v12, v12 row_ror:8 row_mask:0xf bank_mask:0xf
    s_nop 1
    v_add_f32_dpp v12, v12, v12 row_ror:4 row_mask:0xf bank_mask:0xf
    s_nop 1
    v_add_f32_dpp v12, v12, v12 row_ror:2 row_mask:0xf bank_mask:0xf
    s_nop 1
    v_add_f32_dpp v12, v12, v12 row_ror:1 row_mask:0xf bank_mask:0xf
    s_nop 1
    v_add_f32_dpp v12, v12, v12 row_bcast:15 row_mask:0xa bank_mask:0xf
    s_nop 1
    v_add_f32_dpp v12, v12, v12 row_bcast:31 row_mask:0xc bank_mask:0xf
    s_nop 0
    v_readlane_b32 s44, v12, 63
    s_nop 1
    v_mul_f32 v15, s44, v16
    v_cvt_pk_bf16_f32 v14, v14, v14
    v_lshlrev_b32 v14, 16, v14
    v_cvt_pk_bf16_f32 v15, v15, v15
    v_lshlrev_b32 v15, 16, v15
    v_add_f32 v15, 0x3727c5ac, v15
    v_cvt_pk_bf16_f32 v15, v15, v15
    v_lshlrev_b32 v15, 16, v15
    v_sqrt_f32 v15, v15
    s_nop 0
    v_cvt_pk_bf16_f32 v15, v15, v15
    v_lshlrev_b32 v15, 16, v15
    v_rcp_f32 v16, v15
    v_lshlrev_b32 v4, 16, v28
    v_and_b32 v5, 0xffff0000, v28
    v_pk_add_f32 v[4:5], v[4:5], v[14:15] op_sel_hi:[1,0] neg_lo:[0,1] neg_hi:[0,1]
    v_cvt_pk_bf16_f32 v28, v4, v5
    v_lshlrev_b32 v4, 16, v28
    v_and_b32 v5, 0xffff0000, v28
    v_pk_mul_f32 v[4:5], v[4:5], v[16:17] op_sel_hi:[1,0]
    v_cvt_pk_bf16_f32 v28, v4, v5
    v_lshlrev_b32 v6, 16, v29
    v_and_b32 v7, 0xffff0000, v29
    v_pk_add_f32 v[6:7], v[6:7], v[14:15] op_sel_hi:[1,0] neg_lo:[0,1] neg_hi:[0,1]
    v_cvt_pk_bf16_f32 v29, v6, v7
    v_lshlrev_b32 v6, 16, v29
    v_and_b32 v7, 0xffff0000, v29
    v_pk_mul_f32 v[6:7], v[6:7], v[16:17] op_sel_hi:[1,0]
    v_cvt_pk_bf16_f32 v29, v6, v7
    v_lshlrev_b32 v8, 16, v30
    v_and_b32 v9, 0xffff0000, v30
    v_pk_add_f32 v[8:9], v[8:9], v[14:15] op_sel_hi:[1,0] neg_lo:[0,1] neg_hi:[0,1]
    v_cvt_pk_bf16_f32 v30, v8, v9
    v_lshlrev_b32 v8, 16, v30
    v_and_b32 v9, 0xffff0000, v30
    v_pk_mul_f32 v[8:9], v[8:9], v[16:17] op_sel_hi:[1,0]
    v_cvt_pk_bf16_f32 v30, v8, v9
    v_lshlrev_b32 v10, 16, v31
    v_and_b32 v11, 0xffff0000, v31
    v_pk_add_f32 v[10:11], v[10:11], v[14:15] op_sel_hi:[1,0] neg_lo:[0,1] neg_hi:[0,1]
    v_cvt_pk_bf16_f32 v31, v10, v11
    v_lshlrev_b32 v10, 16, v31
    v_and_b32 v11, 0xffff0000, v31
    v_pk_mul_f32 v[10:11], v[10:11], v[16:17] op_sel_hi:[1,0]
    v_cvt_pk_bf16_f32 v31, v10, v11
    s_waitcnt lgkmcnt(0)
    s_mul_i32 s29, s29, 0x9E3779B1
    s_add_u32 s29, s29, 0x7F4A7C15
    s_xor_b32 s59, s59, s29
    v_mov_b32 v3, s29
    v_mov_b32 v21, s59
    s_waitcnt vmcnt(6)
    v_perm_b32 v4, v40, v36, s30
    v_perm_b32 v5, v40, v36, s31
    v_perm_b32 v6, v41, v37, s30
    v_perm_b32 v7, v41, v37, s31
    v_perm_b32 v8, v42, v38, s30
    v_perm_b32 v9, v42, v38, s31
    v_perm_b32 v10, v43, v39, s30
    v_perm_b32 v11, v43, v39, s31
    v_dot2_f32_bf16 v84, v4, v28, 0
    v_dot2_f32_bf16 v85, v5, v28, 0
    v_dot2_f32_bf16 v86, v6, v28, 0
    v_dot2_f32_bf16 v87, v7, v28, 0
    v_dot2_f32_bf16 v88, v8, v28, 0
    v_dot2_f32_bf16 v89, v9, v28, 0
    v_dot2_f32_bf16 v90, v10, v28, 0
    v_dot2_f32_bf16 v91, v11, v28, 0
    s_waitcnt vmcnt(4)
    v_perm_b32 v4, v48, v44, s30
    v_perm_b32 v5, v48, v44, s31
    v_perm_b32 v6, v49, v45, s30
    v_perm_b32 v7, v49, v45, s31
    v_perm_b32 v8, v50, v46, s30
    v_perm_b32 v9, v50, v46, s31
    v_perm_b32 v10, v51, v47, s30
    v_perm_b32 v11, v51, v47, s31
    v_dot2_f32_bf16 v84, v4, v29, v84
    v_dot2_f32_bf16 v85, v5, v29, v85
    v_dot2_f32_bf16 v86, v6, v29, v86
    v_dot2_f32_bf16 v87, v7, v29, v87
    v_dot2_f32_bf16 v88, v8, v29, v88
    v_dot2_f32_bf16 v89, v9, v29, v89
    v_dot2_f32_bf16 v90, v10, v29, v90
    v_dot2_f32_bf16 v91, v11, v29, v91
    s_waitcnt vmcnt(2)
    v_perm_b32 v4, v56, v52, s30
    v_perm_b32 v5, v56, v52, s31
    v_perm_b32 v6, v57, v53, s30
    v_perm_b32 v7, v57, v53, s31
    v_perm_b32 v8, v58, v54, s30
    v_perm_b32 v9, v58, v54, s31
    v_perm_b32 v10, v59, v55, s30
    v_perm_b32 v11, v59, v55, s31
    v_dot2_f32_bf16 v84, v4, v30, v84
    v_dot2_f32_bf16 v85, v5, v30, v85
    v_dot2_f32_bf16 v86, v6, v30, v86
    v_dot2_f32_bf16 v87, v7, v30, v87
    v_dot2_f32_bf16 v88, v8, v30, v88
    v_dot2_f32_bf16 v89, v9, v30, v89
    v_dot2_f32_bf16 v90, v10, v30, v90
    v_dot2_f32_bf16 v91, v11, v30, v91
    s_waitcnt vmcnt(0)
    v_perm_b32 v4, v64, v60, s30
    v_perm_b32 v5, v64, v60, s31
    v_perm_b32 v6, v65, v61, s30
    v_perm_b32 v7, v65, v61, s31
    v_perm_b32 v8, v66, v62, s30
    v_perm_b32 v9, v66, v62, s31
    v_perm_b32 v10, v67, v63, s30
    v_perm_b32 v11, v67, v63, s31
    v_dot2_f32_bf16 v84, v4, v31, v84
    v_dot2_f32_bf16 v85, v5, v31, v85
    v_dot2_f32_bf16 v86, v6, v31, v86
    v_dot2_f32_bf16 v87, v7, v31, v87
    v_dot2_f32_bf16 v88, v8, v31, v88
    v_dot2_f32_bf16 v89, v9, v31, v89
    v_dot2_f32_bf16 v90, v10, v31, v90
    v_dot2_f32_bf16 v91, v11, v31, v91
    v_permlane32_swap_b32 v84, v85
    v_permlane32_swap_b32 v86, v87
    v_permlane32_swap_b32 v88, v89
    v_permlane32_swap_b32 v90, v91
    v_add_f32 v84, v84, v85
    v_add_f32 v86, v86, v87
    v_add_f32 v88, v88, v89
    v_add_f32 v90, v90, v91
    v_permlane16_swap_b32 v84, v86
    s_nop 0
    v_permlane16_swap_b32 v88, v90
    v_add_f32 v84, v84, v86
    v_add_f32 v88, v88, v90
    s_nop 0
    v_add_f32_dpp v84, v84, v84 row_ror:8 row_mask:0xf bank_mask:0xf
    v_add_f32_dpp v88, v88, v88 row_ror:8 row_mask:0xf bank_mask:0xf
    s_nop 0
    v_add_f32_dpp v84, v84, v84 row_ror:4 row_mask:0xf bank_mask:0xf
    v_add_f32_dpp v88, v88, v88 row_ror:4 row_mask:0xf bank_mask:0xf
    s_mov_b32 exec_lo, 0x000f000f
    s_mov_b32 exec_hi, 0x000f000f
    ds_write2_b32 v161, v84, v88 offset0:0 offset1:4
    s_mov_b64 exec, -1
    s_cmp_lg_u32 s28, 0
    s_waitcnt lgkmcnt(0)
    s_barrier
    s_cbranch_scc1 L_noq
    ds_read2_b64 v[4:7], v160 offset0:0 offset1:16
    ds_read2_b64 v[8:11], v160 offset0:32 offset1:48
    v_mov_b32 v17, s59
    v_mov_b32 v19, s59
    s_waitcnt lgkmcnt(0)
    v_pk_add_f32 v[4:5], v[4:5], v[6:7]
    v_pk_add_f32 v[8:9], v[8:9], v[10:11]
    v_add_f32 v16, v4, v8
    v_add_f32 v18, v5, v9
    v_cvt_pk_bf16_f32 v16, v16, v18
    s_mov_b64 exec, 0xffff
    global_store_dwordx2 v159, v[16:17], s[24:25]
    s_mov_b32 exec_lo, 0xffff0000
    global_store_dword v159, v17, s[24:25]
    s_mov_b32 exec_lo, 0xffff
    global_store_dwordx2 v159, v[16:17], s[60:61] sc1
    s_mov_b64 exec, -1
L_noq:
    s_barrier
    s_barrier
    global_load_dword v20, v172, s[8:9]
    s_mov_b64 exec, -1
    v_mov_b32 v17, s29
    v_mov_b32 v19, s29
    s_lshl_b32 s35, s39, 17
    s_lshl_b32 s36, s38, 15
    s_add_u32 s35, s35, s36
    s_add_u32 s35, s35, 384
    v_lshl_add_u32 v4, v22, 13, s35
    v_lshl_add_u32 v4, v1, 10, v4
    s_mov_b64 exec, 0xff
    global_load_dword v20, v4, s[12:13]
    s_mov_b64 exec, -1
    global_load_dword v20, v167, s[24:25]
    global_load_dword v20, v169, s[24:25]
    s_barrier
    global_load_dword v52, v158, s[12:13] offset:-4096 nt
    global_load_dword v53, v158, s[12:13] offset:-3072 nt
    global_load_dword v54, v158, s[12:13] offset:-2048 nt
    global_load_dword v55, v158, s[12:13] offset:-1024 nt
    global_load_dword v56, v158, s[12:13] offset:0 nt
    global_load_dword v57, v158, s[12:13] offset:1024 nt
    global_load_dword v58, v158, s[12:13] offset:2048 nt
    global_load_dword v59, v158, s[12:13] offset:3072 nt
    v_add_u32 v158, 0x2000, v158
    global_load_dword v60, v158, s[12:13] offset:-4096 nt
    global_load_dword v61, v158, s[12:13] offset:-3072 nt
    global_load_dword v62, v158, s[12:13] offset:-2048 nt
    global_load_dword v63, v158, s[12:13] offset:-1024 nt
    global_load_dword v64, v158, s[12:13] offset:0 nt
    global_load_dword v65, v158, s[12:13] offset:1024 nt
    global_load_dword v66, v158, s[12:13] offset:2048 nt
    global_load_dword v67, v158, s[12:13] offset:3072 nt
    v_add_u32 v158, 0x2000, v158
    global_load_dword v68, v158, s[12:13] offset:-4096 nt
    global_load_dword v69, v158, s[12:13] offset:-3072 nt
    global_load_dword v70, v158, s[12:13] offset:-2048 nt
    global_load_dword v71, v158, s[12:13] offset:-1024 nt
    global_load_dword v72, v158, s[12:13] offset:0 nt
    global_load_dword v73, v158, s[12:13] offset:1024 nt
    global_load_dword v74, v158, s[12:13] offset:2048 nt
    global_load_dword v75, v158, s[12:13] offset:3072 nt
    v_add_u32 v158, 0x2000, v158
    global_load_dword v76, v158, s[12:13] offset:-4096 nt
    global_load_dword v77, v158, s[12:13] offset:-3072 nt
    global_load_dword v78, v158, s[12:13] offset:-2048 nt
    global_load_dword v79, v158, s[12:13] offset:-1024 nt
    global_load_dword v80, v158, s[12:13] offset:0 nt
    global_load_dword v81, v158, s[12:13] offset:1024 nt
    global_load_dword v82, v158, s[12:13] offset:2048 nt
    global_load_dword v83, v158, s[12:13] offset:3072 nt
    s_waitcnt vmcnt(24)
    v_perm_b32 v92, v53, v52, s30
    v_perm_b32 v93, v53, v52, s31
    v_perm_b32 v94, v55, v54, s30
    v_perm_b32 v95, v55, v54, s31
    v_perm_b32 v96, v57, v56, s30
    v_perm_b32 v97, v57, v56, s31
    v_perm_b32 v98, v59, v58, s30
    v_perm_b32 v99, v59, v58, s31
    s_waitcnt vmcnt(16)
    v_perm_b32 v100, v61, v60, s30
    v_perm_b32 v101, v61, v60, s31
    v_perm_b32 v102, v63, v62, s30
    v_perm_b32 v103, v63, v62, s31
    v_perm_b32 v104, v65, v64, s30
    v_perm_b32 v105, v65, v64, s31
    v_perm_b32 v106, v67, v66, s30
    v_perm_b32 v107, v67, v66, s31
    s_waitcnt vmcnt(8)
    global_load_dwordx4 v[124:127], v163, s[24:25] offset:0 sc1
    global_load_dwordx4 v[128:131], v163, s[24:25] offset:512 sc1
    global_load_dwordx4 v[132:135], v163, s[24:25] offset:1024 sc1
    global_load_dwordx4 v[136:139], v163, s[24:25] offset:1536 sc1
    global_load_dwordx4 v[140:143], v162, s[24:25] offset:0 sc1
    global_load_dwordx4 v[144:147], v162, s[24:25] offset:1024 sc1
    global_load_dwordx4 v[148:151], v162, s[24:25] offset:2048 sc1
    global_load_dwordx4 v[152:155], v162, s[24:25] offset:3072 sc1
    v_perm_b32 v108, v69, v68, s30
    v_perm_b32 v109, v69, v68, s31
    v_perm_b32 v110, v71, v70, s30
    v_perm_b32 v111, v71, v70, s31
    v_perm_b32 v112, v73, v72, s30
    v_perm_b32 v113, v73, v72, s31
    v_perm_b32 v114, v75, v74, s30
    v_perm_b32 v115, v75, v74, s31
    s_waitcnt vmcnt(8)
    v_perm_b32 v116, v77, v76, s30
    v_perm_b32 v117, v77, v76, s31
    v_perm_b32 v118, v79, v78, s30
    v_perm_b32 v119, v79, v78, s31
    v_perm_b32 v120, v81, v80, s30
    v_perm_b32 v121, v81, v80, s31
    v_perm_b32 v122, v83, v82, s30
    v_perm_b32 v123, v83, v82, s31
    v_mov_b32 v12, 0
    v_mov_b32 v13, 0
    v_mov_b32 v14, 0
    v_mov_b32 v15, 0
    s_mov_b64 s[22:23], -1
    s_waitcnt vmcnt(4)
    s_branch L_mlf_2
L_mll_1:
    s_sub_u32 s14, s14, 1
    s_cbranch_scc1 L_end
    s_mov_b64 exec, s[22:23]
    global_load_dwordx4 v[124:127], v163, s[24:25] offset:0 sc1
    global_load_dwordx4 v[128:131], v163, s[24:25] offset:512 sc1
    global_load_dwordx4 v[132:135], v163, s[24:25] offset:1024 sc1
    global_load_dwordx4 v[136:139], v163, s[24:25] offset:1536 sc1
    s_waitcnt vmcnt(0)
L_mlf_2:
    v_cmpx_eq_u32 vcc, v3, v125
    v_cmpx_eq_u32 vcc, v3, v127
    v_cmpx_eq_u32 vcc, v3, v129
    v_cmpx_eq_u32 vcc, v3, v131
    v_cmpx_eq_u32 vcc, v3, v133
    v_cmpx_eq_u32 vcc, v3, v135
    v_cmpx_eq_u32 vcc, v3, v137
    v_cmpx_eq_u32 vcc, v3, v139
    s_andn2_b64 s[22:23], s[22:23], exec
    s_cbranch_scc1 L_mll_1
    s_mov_b64 exec, -1
    s_waitcnt vmcnt(0)
    v_cmpx_eq_u32 vcc, v3, v141
    v_cmpx_eq_u32 vcc, v3, v143
    v_cmpx_eq_u32 vcc, v3, v145
    v_cmpx_eq_u32 vcc, v3, v147
    v_cmpx_eq_u32 vcc, v3, v149
    v_cmpx_eq_u32 vcc, v3, v151
    v_cmpx_eq_u32 vcc, v3, v153
    v_cmpx_eq_u32 vcc, v3, v155
    s_andn2_b64 exec, -1, exec
    s_cbranch_scc0 L_noo
    global_load_dwordx4 v[140:143], v162, s[24:25] offset:0 sc1
    global_load_dwordx4 v[144:147], v162, s[24:25] offset:1024 sc1
    global_load_dwordx4 v[148:151], v162, s[24:25] offset:2048 sc1
    global_load_dwordx4 v[152:155], v162, s[24:25] offset:3072 sc1
L_noo:
    s_cselect_b32 s47, 1, 0
    s_mov_b64 exec, -1
    v_max3_f32 v4, v124, v128, v132
    v_max_f32 v4, v4, v136
    v_mov_b32 v6, v4
    s_nop 1
    v_permlane32_swap_b32 v4, v6
    v_max_f32 v4, v4, v6
    v_mov_b32 v6, v4
    s_nop 1
    v_permlane16_swap_b32 v4, v6
    v_max_f32 v4, v4, v6
    v_sub_f32 v124, v124, v4
    v_sub_f32 v128, v128, v4
    v_sub_f32 v132, v132, v4
    v_sub_f32 v136, v136, v4
    v_mul_f32 v124, s50, v124
    v_mul_f32 v128, s50, v128
    v_mul_f32 v132, s50, v132
    v_mul_f32 v136, s50, v136
    v_exp_f32 v124, v124
    v_exp_f32 v128, v128
    v_exp_f32 v132, v132
    v_exp_f32 v136, v136
    v_mul_f32 v5, v124, v126
    v_fmac_f32 v5, v128, v130
    v_fmac_f32 v5, v132, v134
    v_fmac_f32 v5, v136, v138
    v_mov_b32 v6, v5
    s_nop 1
    v_permlane32_swap_b32 v5, v6
    v_add_f32 v5, v5, v6
    v_mov_b32 v6, v5
    s_nop 1
    v_permlane16_swap_b32 v5, v6
    v_add_f32 v5, v5, v6
    v_rcp_f32 v5, v5
    s_cmp_eq_u32 s47, 0
    s_cbranch_scc1 L_ook
    s_mov_b64 s[22:23], -1
    s_waitcnt vmcnt(0)
    s_branch L_of_4
L_ol_3:
    s_sub_u32 s14, s14, 1
    s_cbranch_scc1 L_end
    s_mov_b64 exec, s[22:23]
    global_load_dwordx4 v[140:143], v162, s[24:25] offset:0 sc1
    global_load_dwordx4 v[144:147], v162, s[24:25] offset:1024 sc1
    global_load_dwordx4 v[148:151], v162, s[24:25] offset:2048 sc1
    global_load_dwordx4 v[152:155], v162, s[24:25] offset:3072 sc1
    s_waitcnt vmcnt(0)
L_of_4:
    v_cmpx_eq_u32 vcc, v3, v141
    v_cmpx_eq_u32 vcc, v3, v143
    v_cmpx_eq_u32 vcc, v3, v145
    v_cmpx_eq_u32 vcc, v3, v147
    v_cmpx_eq_u32 vcc, v3, v149
    v_cmpx_eq_u32 vcc, v3, v151
    v_cmpx_eq_u32 vcc, v3, v153
    v_cmpx_eq_u32 vcc, v3, v155
    s_andn2_b64 s[22:23], s[22:23], exec
    s_cbranch_scc1 L_ol_3
    s_mov_b64 exec, -1
L_ook:
    v_mul_f32 v6, v124, v140
    v_mul_f32 v7, v124, v142
    v_fmac_f32 v6, v128, v144
    v_fmac_f32 v7, v128, v146
    v_fmac_f32 v6, v132, v148
    v_fmac_f32 v7, v132, v150
    v_fmac_f32 v6, v136, v152
    v_fmac_f32 v7, v136, v154
    s_nop 1
    v_permlane32_swap_b32 v6, v7
    v_add_f32 v6, v6, v7
    v_mov_b32 v7, v6
    s_nop 1
    v_permlane16_swap_b32 v6, v7
    v_add_f32 v6, v6, v7
    v_mul_f32 v6, v6, v5
    v_mul_f32 v7, 1.0, v6
    s_nop 1
    v_permlane32_swap_b32 v6, v7
    v_cvt_pk_bf16_f32 v6, v6, v7
    s_nop 0
    s_nop 0
    v_dot2c_f32_bf16_dpp v12, v6, v92 row_newbcast:0 row_mask:0xf bank_mask:0xf
    v_dot2c_f32_bf16_dpp v13, v6, v93 row_newbcast:0 row_mask:0xf bank_mask:0xf
    v_dot2c_f32_bf16_dpp v14, v6, v94 row_newbcast:1 row_mask:0xf bank_mask:0xf
    v_dot2c_f32_bf16_dpp v15, v6, v95 row_newbcast:1 row_mask:0xf bank_mask:0xf
    v_dot2c_f32_bf16_dpp v12, v6, v96 row_newbcast:2 row_mask:0xf bank_mask:0xf
    v_dot2c_f32_bf16_dpp v13, v6, v97 row_newbcast:2 row_mask:0xf bank_mask:0xf
    v_dot2c_f32_bf16_dpp v14, v6, v98 row_newbcast:3 row_mask:0xf bank_mask:0xf
    v_dot2c_f32_bf16_dpp v15, v6, v99 row_newbcast:3 row_mask:0xf bank_mask:0xf
    v_dot2c_f32_bf16_dpp v12, v6, v100 row_newbcast:4 row_mask:0xf bank_mask:0xf
    v_dot2c_f32_bf16_dpp v13, v6, v101 row_newbcast:4 row_mask:0xf bank_mask:0xf
    v_dot2c_f32_bf16_dpp v14, v6, v102 row_newbcast:5 row_mask:0xf bank_mask:0xf
    v_dot2c_f32_bf16_dpp v15, v6, v103 row_newbcast:5 row_mask:0xf bank_mask:0xf
    v_dot2c_f32_bf16_dpp v12, v6, v104 row_newbcast:6 row_mask:0xf bank_mask:0xf
    v_dot2c_f32_bf16_dpp v13, v6, v105 row_newbcast:6 row_mask:0xf bank_mask:0xf
    v_dot2c_f32_bf16_dpp v14, v6, v106 row_newbcast:7 row_mask:0xf bank_mask:0xf
    v_dot2c_f32_bf16_dpp v15, v6, v107 row_newbcast:7 row_mask:0xf bank_mask:0xf
    v_dot2c_f32_bf16_dpp v12, v6, v108 row_newbcast:8 row_mask:0xf bank_mask:0xf
    v_dot2c_f32_bf16_dpp v13, v6, v109 row_newbcast:8 row_mask:0xf bank_mask:0xf
    v_dot2c_f32_bf16_dpp v14, v6, v110 row_newbcast:9 row_mask:0xf bank_mask:0xf
    v_dot2c_f32_bf16_dpp v15, v6, v111 row_newbcast:9 row_mask:0xf bank_mask:0xf
    v_dot2c_f32_bf16_dpp v12, v6, v112 row_newbcast:10 row_mask:0xf bank_mask:0xf
    v_dot2c_f32_bf16_dpp v13, v6, v113 row_newbcast:10 row_mask:0xf bank_mask:0xf
    v_dot2c_f32_bf16_dpp v14, v6, v114 row_newbcast:11 row_mask:0xf bank_mask:0xf
    v_dot2c_f32_bf16_dpp v15, v6, v115 row_newbcast:11 row_mask:0xf bank_mask:0xf
    v_dot2c_f32_bf16_dpp v12, v6, v116 row_newbcast:12 row_mask:0xf bank_mask:0xf
    v_dot2c_f32_bf16_dpp v13, v6, v117 row_newbcast:12 row_mask:0xf bank_mask:0xf
    v_dot2c_f32_bf16_dpp v14, v6, v118 row_newbcast:13 row_mask:0xf bank_mask:0xf
    v_dot2c_f32_bf16_dpp v15, v6, v119 row_newbcast:13 row_mask:0xf bank_mask:0xf
    v_dot2c_f32_bf16_dpp v12, v6, v120 row_newbcast:14 row_mask:0xf bank_mask:0xf
    v_dot2c_f32_bf16_dpp v13, v6, v121 row_newbcast:14 row_mask:0xf bank_mask:0xf
    v_dot2c_f32_bf16_dpp v14, v6, v122 row_newbcast:15 row_mask:0xf bank_mask:0xf
    v_dot2c_f32_bf16_dpp v15, v6, v123 row_newbcast:15 row_mask:0xf bank_mask:0xf
    s_nop 2
    v_pk_add_f32 v[12:13], v[12:13], v[14:15]
    s_cmp_lg_u32 s28, 0
    ds_write_b64 v165, v[12:13] offset:4096
    s_waitcnt lgkmcnt(0)
    s_barrier
    s_cbranch_scc1 L_out
    ds_read2st64_b64 v[4:7], v164 offset0:8 offset1:9
    ds_read2st64_b64 v[8:11], v164 offset0:10 offset1:11
    s_waitcnt lgkmcnt(0)
    v_pk_add_f32 v[4:5], v[4:5], v[6:7]
    v_pk_add_f32 v[8:9], v[8:9], v[10:11]
    v_add_f32 v16, v4, v8
    v_add_f32 v18, v5, v9
    global_store_dwordx4 v168, v[16:19], s[24:25] sc1
    s_mov_b64 exec, 1
    global_store_dword v169, v3, s[24:25]
    s_endpgm
L_ffn2:
    s_lshr_b32 s33, s32, 1
    s_mul_i32 s35, s34, 917504
    s_mul_i32 s36, s26, 448
    s_add_u32 s35, s35, s36
    s_lshl_b32 s36, s33, 6
    s_add_u32 s35, s35, s36
    v_mul_u32_u24 v173, 14336, v14
    v_add3_u32 v173, v173, v16, s35
    v_add_u32 v156, 7168, v173
    s_add_u32 s60, s24, 0x10000
    s_addc_u32 s61, s25, 0
    v_and_b32 v161, 3, v0
    v_lshlrev_b32 v161, 5, v161
    v_bfe_u32 v8, v0, 4, 1
    v_lshl_add_u32 v161, v8, 3, v161
    v_bfe_u32 v8, v0, 5, 1
    v_lshl_add_u32 v161, v8, 2, v161
    v_lshl_add_u32 v161, v22, 7, v161
    v_and_b32 v8, 15, v0
    v_lshlrev_b32 v160, 3, v8
    s_lshl_b32 s35, s26, 12
    s_add_u32 s35, s35, 0xc4000
    s_lshl_b32 s36, s32, 8
    s_add_u32 s36, s35, s36
    v_add_u32 v159, s36, v2
    s_waitcnt vmcnt(0)
    v_lshlrev_b32 v4, 16, v24
    v_and_b32 v5, 0xffff0000, v24
    v_lshlrev_b32 v6, 16, v25
    v_and_b32 v7, 0xffff0000, v25
    v_lshlrev_b32 v8, 16, v26
    v_and_b32 v9, 0xffff0000, v26
    v_lshlrev_b32 v10, 16, v27
    v_and_b32 v11, 0xffff0000, v27
    v_pk_add_f32 v[12:13], v[4:5], v[6:7]
    v_pk_add_f32 v[14:15], v[8:9], v[10:11]
    v_pk_add_f32 v[12:13], v[12:13], v[14:15]
    v_add_f32 v12, v12, v13
    s_nop 1
    v_add_f32_dpp v12, v12, v12 row_ror:8 row_mask:0xf bank_mask:0xf
    s_nop 1
    v_add_f32_dpp v12, v12, v12 row_ror:4 row_mask:0xf bank_mask:0xf
    s_nop 1
    v_add_f32_dpp v12, v12, v12 row_ror:2 row_mask:0xf bank_mask:0xf
    s_nop 1
    v_add_f32_dpp v12, v12, v12 row_ror:1 row_mask:0xf bank_mask:0xf
    s_nop 1
    v_add_f32_dpp v12, v12, v12 row_bcast:15 row_mask:0xa bank_mask:0xf
    s_nop 1
    v_add_f32_dpp v12, v12, v12 row_bcast:31 row_mask:0xc bank_mask:0xf
    s_nop 0
    v_readlane_b32 s44, v12, 63
    s_nop 1
    v_mov_b32 v16, 0x3b000000
    v_mul_f32 v14, s44, v16
    v_pk_add_f32 v[4:5], v[4:5], v[14:15] op_sel_hi:[1,0] neg_lo:[0,1] neg_hi:[0,1]
    v_pk_add_f32 v[6:7], v[6:7], v[14:15] op_sel_hi:[1,0] neg_lo:[0,1] neg_hi:[0,1]
    v_pk_add_f32 v[8:9], v[8:9], v[14:15] op_sel_hi:[1,0] neg_lo:[0,1] neg_hi:[0,1]
    v_pk_add_f32 v[10:11], v[10:11], v[14:15] op_sel_hi:[1,0] neg_lo:[0,1] neg_hi:[0,1]
    v_pk_mul_f32 v[12:13], v[4:5], v[4:5]
    v_pk_fma_f32 v[12:13], v[6:7], v[6:7], v[12:13]
    v_pk_fma_f32 v[12:13], v[8:9], v[8:9], v[12:13]
    v_pk_fma_f32 v[12:13], v[10:11], v[10:11], v[12:13]
    v_add_f32 v12, v12, v13
    s_nop 1
    v_add_f32_dpp v12, v12, v12 row_ror:8 row_mask:0xf bank_mask:0xf
    s_nop 1
    v_add_f32_dpp v12, v12, v12 row_ror:4 row_mask:0xf bank_mask:0xf
    s_nop 1
    v_add_f32_dpp v12, v12, v12 row_ror:2 row_mask:0xf bank_mask:0xf
    s_nop 1
    v_add_f32_dpp v12, v12, v12 row_ror:1 row_mask:0xf bank_mask:0xf
    s_nop 1
    v_add_f32_dpp v12, v12, v12 row_bcast:15 row_mask:0xa bank_mask:0xf
    s_nop 1
    v_add_f32_dpp v12, v12, v12 row_bcast:31 row_mask:0xc bank_mask:0xf
    s_nop 0
    v_readlane_b32 s44, v12, 63
    s_nop 1
    v_mul_f32 v15, s44, v16
    v_cvt_pk_bf16_f32 v14, v14, v14
    v_lshlrev_b32 v14, 16, v14
    v_cvt_pk_bf16_f32 v15, v15, v15
    v_lshlrev_b32 v15, 16, v15
    v_add_f32 v15, 0x3727c5ac, v15
    v_cvt_pk_bf16_f32 v15, v15, v15
    v_lshlrev_b32 v15, 16, v15
    v_sqrt_f32 v15, v15
    s_nop 0
    v_cvt_pk_bf16_f32 v15, v15, v15
    v_lshlrev_b32 v15, 16, v15
    v_rcp_f32 v16, v15
    v_lshlrev_b32 v4, 16, v32
    v_and_b32 v5, 0xffff0000, v32
    v_pk_add_f32 v[4:5], v[4:5], v[14:15] op_sel_hi:[1,0] neg_lo:[0,1] neg_hi:[0,1]
    v_cvt_pk_bf16_f32 v32, v4, v5
    v_lshlrev_b32 v4, 16, v32
    v_and_b32 v5, 0xffff0000, v32
    v_pk_mul_f32 v[4:5], v[4:5], v[16:17] op_sel_hi:[1,0]
    v_cvt_pk_bf16_f32 v32, v4, v5
    v_lshlrev_b32 v6, 16, v33
    v_and_b32 v7, 0xffff0000, v33
    v_pk_add_f32 v[6:7], v[6:7], v[14:15] op_sel_hi:[1,0] neg_lo:[0,1] neg_hi:[0,1]
    v_cvt_pk_bf16_f32 v33, v6, v7
    v_lshlrev_b32 v6, 16, v33
    v_and_b32 v7, 0xffff0000, v33
    v_pk_mul_f32 v[6:7], v[6:7], v[16:17] op_sel_hi:[1,0]
    v_cvt_pk_bf16_f32 v33, v6, v7
    s_waitcnt lgkmcnt(0)
    s_mul_i32 s29, s29, 0x9E3779B1
    s_add_u32 s29, s29, 0x7F4A7C15
    s_xor_b32 s59, s59, s29
    v_mov_b32 v3, s29
    v_mov_b32 v21, s59
    s_barrier
    s_barrier
    global_load_dwordx4 v[68:71], v173, s[16:17] offset:0
    global_load_dwordx4 v[72:75], v173, s[16:17] offset:3584
    global_load_dwordx4 v[76:79], v156, s[16:17] offset:0
    global_load_dwordx4 v[80:83], v156, s[16:17] offset:3584
    s_barrier
    s_barrier
    s_waitcnt vmcnt(2)
    v_perm_b32 v4, v72, v68, s30
    v_perm_b32 v5, v72, v68, s31
    v_perm_b32 v6, v73, v69, s30
    v_perm_b32 v7, v73, v69, s31
    v_perm_b32 v8, v74, v70, s30
    v_perm_b32 v9, v74, v70, s31
    v_perm_b32 v10, v75, v71, s30
    v_perm_b32 v11, v75, v71, s31
    v_dot2_f32_bf16 v84, v4, v32, 0
    v_dot2_f32_bf16 v85, v5, v32, 0
    v_dot2_f32_bf16 v86, v6, v32, 0
    v_dot2_f32_bf16 v87, v7, v32, 0
    v_dot2_f32_bf16 v88, v8, v32, 0
    v_dot2_f32_bf16 v89, v9, v32, 0
    v_dot2_f32_bf16 v90, v10, v32, 0
    v_dot2_f32_bf16 v91, v11, v32, 0
    s_waitcnt vmcnt(0)
    v_perm_b32 v4, v80, v76, s30
    v_perm_b32 v5, v80, v76, s31
    v_perm_b32 v6, v81, v77, s30
    v_perm_b32 v7, v81, v77, s31
    v_perm_b32 v8, v82, v78, s30
    v_perm_b32 v9, v82, v78, s31
    v_perm_b32 v10, v83, v79, s30
    v_perm_b32 v11, v83, v79, s31
    v_dot2_f32_bf16 v84, v4, v33, v84
    v_dot2_f32_bf16 v85, v5, v33, v85
    v_dot2_f32_bf16 v86, v6, v33, v86
    v_dot2_f32_bf16 v87, v7, v33, v87
    v_dot2_f32_bf16 v88, v8, v33, v88
    v_dot2_f32_bf16 v89, v9, v33, v89
    v_dot2_f32_bf16 v90, v10, v33, v90
    v_dot2_f32_bf16 v91, v11, v33, v91
    v_permlane32_swap_b32 v84, v85
    v_permlane32_swap_b32 v86, v87
    v_permlane32_swap_b32 v88, v89
    v_permlane32_swap_b32 v90, v91
    v_add_f32 v84, v84, v85
    v_add_f32 v86, v86, v87
    v_add_f32 v88, v88, v89
    v_add_f32 v90, v90, v91
    v_permlane16_swap_b32 v84, v86
    s_nop 0
    v_permlane16_swap_b32 v88, v90
    v_add_f32 v84, v84, v86
    v_add_f32 v88, v88, v90
    s_nop 0
    v_add_f32_dpp v84, v84, v84 row_ror:8 row_mask:0xf bank_mask:0xf
    v_add_f32_dpp v88, v88, v88 row_ror:8 row_mask:0xf bank_mask:0xf
    s_nop 0
    v_add_f32_dpp v84, v84, v84 row_ror:4 row_mask:0xf bank_mask:0xf
    v_add_f32_dpp v88, v88, v88 row_ror:4 row_mask:0xf bank_mask:0xf
    s_mov_b32 exec_lo, 0x000f000f
    s_mov_b32 exec_hi, 0x000f000f
    ds_write2_b32 v161, v84, v88 offset0:128 offset1:132
    s_mov_b64 exec, -1
    v_mov_b32 v12, 0
    v_mov_b32 v13, 1
    s_mov_b64 exec, 1
    ds_add_rtn_u32 v14, v12, v13 offset:1536
    s_mov_b64 exec, -1
    s_waitcnt lgkmcnt(0)
    v_readfirstlane_b32 s45, v14
    s_cmp_lg_u32 s45, 3
    s_cbranch_scc1 L_noh
    ds_read2_b64 v[4:7], v160 offset0:64 offset1:80
    ds_read2_b64 v[8:11], v160 offset0:96 offset1:112
    v_mov_b32 v17, s59
    v_mov_b32 v19, s59
    s_waitcnt lgkmcnt(0)
    v_pk_add_f32 v[4:5], v[4:5], v[6:7]
    v_pk_add_f32 v[8:9], v[8:9], v[10:11]
    v_add_f32 v16, v4, v8
    v_add_f32 v18, v5, v9
    s_mov_b64 exec, 0xffff
    global_store_dwordx4 v159, v[16:19], s[24:25]
    global_store_dwordx4 v159, v[16:19], s[60:61] sc1
    s_mov_b64 exec, -1
L_noh:
    s_barrier
    s_endpgm
L_out:
L_end:
    s_endpgm
L_qs_7:
    s_mov_b32 s0, 0
L_ql_8:
    s_sub_u32 s14, s14, 1
    s_cbranch_scc1 L_end
    s_add_u32 s0, s0, 1
    s_and_b32 s62, s0, 3
    s_cmp_eq_u32 s62, 3
    s_cselect_b32 s62, s60, s24
    s_cselect_b32 s63, s61, s25
    s_mov_b64 exec, s[22:23]
    global_load_dwordx4 v[104:107], v125, s[62:63] offset:0 sc1
    global_load_dwordx4 v[108:111], v125, s[62:63] offset:16 sc1
    s_waitcnt vmcnt(0)
    v_xor_b32 v4, v3, v105
    v_cmpx_gt_u32 vcc, 16, v4
    v_xor_b32 v4, v3, v107
    v_cmpx_gt_u32 vcc, 16, v4
    v_xor_b32 v4, v3, v109
    v_cmpx_gt_u32 vcc, 16, v4
    v_xor_b32 v4, v3, v111
    v_cmpx_gt_u32 vcc, 16, v4
    s_mov_b64 s[56:57], exec
    v_cmpx_eq_u32 vcc, v21, v105
    v_cmpx_eq_u32 vcc, v21, v107
    v_cmpx_eq_u32 vcc, v21, v109
    v_cmpx_eq_u32 vcc, v21, v111
    s_cmp_eq_u64 s[56:57], exec
    s_cselect_b32 s3, s3, 0
    s_andn2_b64 s[22:23], s[22:23], s[56:57]
    s_cbranch_scc1 L_ql_8
    s_mov_b64 exec, -1
    s_branch L_qk_9
L_st_10:
    global_store_dwordx4 v127, v[16:19], s[24:25] sc1
    s_branch L_stb_11
L_st_16:
    global_store_dwordx4 v161, v[16:19], s[24:25] sc1
    s_branch L_stb_17
L_hs_18:
    s_mov_b32 s0, 0
L_hl_19:
    s_sub_u32 s14, s14, 1
    s_cbranch_scc1 L_end
    s_add_u32 s0, s0, 1
    s_and_b32 s62, s0, 3
    s_cmp_eq_u32 s62, 3
    s_cselect_b32 s62, s60, s24
    s_cselect_b32 s63, s61, s25
    s_mov_b64 exec, s[22:23]
    global_load_dwordx2 v[188:189], v184, s[62:63] sc1
    s_waitcnt vmcnt(0)
    v_xor_b32 v4, v3, v189
    v_cmpx_gt_u32 vcc, 16, v4
    s_mov_b64 s[56:57], exec
    v_cmpx_eq_u32 vcc, v21, v189
    s_cmp_eq_u64 s[56:57], exec
    s_cselect_b32 s3, s3, 0
    s_andn2_b64 s[22:23], s[22:23], s[56:57]
    s_cbranch_scc1 L_hl_19
    s_mov_b64 exec, -1
    s_branch L_hk_20
L_code_end:
.section .rodata,"a"
.p2align 6
.amdhsa_kernel parallel_sum__sliding_block_cached__dense_activation_silu__decode_kernel
  .amdhsa_next_free_vgpr 192
  .amdhsa_next_free_sgpr 64
  .amdhsa_accum_offset 192
  .amdhsa_group_segment_fixed_size 0
  .amdhsa_kernarg_size 88
  .amdhsa_user_sgpr_count 2
  .amdhsa_user_sgpr_kernarg_segment_ptr 1
  .amdhsa_system_sgpr_workgroup_id_x 1
  .amdhsa_float_denorm_mode_32 3
  .amdhsa_float_denorm_mode_16_64 3
.end_amdhsa_kernel
```
